```python
import torch

def _softmax(x, axis=-1):
    return torch.softmax(x, dim=axis)
def _gelu(x):
    return torch.nn.functional.gelu(x, approximate="tanh")
def _silu(x):
    return torch.nn.functional.silu(x)
def _sigmoid(x):
    return torch.sigmoid(x)
def _layernorm(x, axis=-1, eps=1e-5):
    m = x.mean(dim=axis, keepdim=True)
    v = x.var(dim=axis, keepdim=True, unbiased=False)
    return (x - m) / torch.sqrt(v + eps)
def _scatter_add(tgt, idx, src, axis=0):
    return tgt.clone().index_add_(axis, idx, src)
def _segment_sum(src, seg, n):
    out = torch.zeros((n,) + src.shape[1:], dtype=src.dtype)
    return out.index_add_(0, seg, src)
def _pad(x, pw):
    flat = tuple(v for pair in reversed(pw) for v in pair)
    return torch.nn.functional.pad(x, flat)

kernel_name = 'recurrent_scan__ssm_conv_s4d__dense_activation_silu__prompt'

def setup_inputs():

    _w = (lambda a: (lambda t: t.to(torch.bfloat16) if t.is_floating_point() else t)(torch.as_tensor(a)))
    def _A_setup():
        Bsz, L, D, N = 1, 2048, 512, 128
        return {
            "u": _w((lambda *s: torch.randn(*s, dtype=torch.bfloat16) * 0.05)(Bsz, L, D)),
            "log_A_real": _w((lambda *s: torch.randn(*s, dtype=torch.bfloat16) * 6.4)(D, N) * 0.5),
            "A_imag": _w((lambda *s: torch.randn(*s, dtype=torch.bfloat16) * 0.2)(D, N) * 3.14),
            "C_real": _w((lambda *s: torch.randn(*s, dtype=torch.bfloat16) * 0.2)(D, N) / N ** 0.5),
            "C_imag": _w((lambda *s: torch.randn(*s, dtype=torch.bfloat16) * 0.2)(D, N) / N ** 0.5),
            "log_dt": _w((lambda *s: torch.randn(*s, dtype=torch.bfloat16) * 0.2)(D) * 0.5 - 4.0),
            "D_skip": _w((lambda *s: torch.randn(*s, dtype=torch.bfloat16) * 0.2)(D)),
        }
    _A_in = _A_setup()

    def _B_setup():
        B, S, D, F = 1, 2048, 512, 1376
        return {
            "x": _w((lambda *s: torch.randn(*s, dtype=torch.bfloat16) * 0.05)(B, S, D)),
            "w1": _w((lambda *s: torch.randn(*s, dtype=torch.bfloat16) * 0.8)(D, F) * (D ** -0.5)),
            "w2": _w((lambda *s: torch.randn(*s, dtype=torch.bfloat16) * 0.1)(F, D) * (F ** -0.5)),
        }
    _B_in = _B_setup()

    return {
        "A_u": _A_in["u"],
        "A_log_A_real": _A_in["log_A_real"],
        "A_A_imag": _A_in["A_imag"],
        "A_C_real": _A_in["C_real"],
        "A_C_imag": _A_in["C_imag"],
        "A_log_dt": _A_in["log_dt"],
        "A_D_skip": _A_in["D_skip"],
        "B_x": _B_in["x"],
        "B_w1": _B_in["w1"],
        "B_w2": _B_in["w2"],
    }

def reference(A_u, A_log_A_real, A_A_imag, A_C_real, A_C_imag, A_log_dt, A_D_skip, B_x, B_w1, B_w2):
    def _A_ref(u, log_A_real, A_imag, C_real, C_imag, log_dt, D_skip):
        L = u.shape[1]
        dt = torch.exp(log_dt)
        A = -torch.exp(log_A_real) + 1j * A_imag
        C = (C_real + 1j * C_imag) * dt[:, None]
        pos = (lambda x, dt: x.to(dt))(torch.arange(L), log_dt.dtype)
        P = torch.exp((A * dt[:, None])[:, :, None] * pos[None, None, :])
        K = 2.0 * torch.einsum("dn,dnl->dl", C, P).real
        L2 = 2 * L
        u_t = (lambda x, *d: x.permute(*d))(u, 0, 2, 1)
        Kf = (lambda x, *a, **k: torch.fft.rfft(x.float(), *a, **k))(K, L2)
        Uf = (lambda x, *a, **k: torch.fft.rfft(x.float(), *a, **k))(u_t, L2)
        y = (lambda x, *a, **k: torch.fft.irfft(x, *a, **k).to(torch.bfloat16))(Uf * Kf[None, :, :], L2)[:, :, :L]
        y = (lambda x, *d: x.permute(*d))(y, 0, 2, 1)
        return y + u * D_skip[None, None, :]

    def _B_ref(x, w1, w2):
        h = torch.einsum("bsd,df->bsf", x, w1)
        h = _silu(h)
        out = torch.einsum("bsf,fd->bsd", h, w2)
        return out

    x = A_u
    xn = _layernorm(x, axis=-1)
    s = _A_ref(xn, A_log_A_real, A_A_imag, A_C_real, A_C_imag, A_log_dt, A_D_skip)
    g = _silu(_B_ref(xn, B_w1, B_w2))
    return x + s * g
```

```asm
; @launch grid=(256,1,1) block=(512,1,1) lds=163072
.amdgcn_target "amdgcn-amd-amdhsa--gfx950"
.text
.globl recurrent_scan__ssm_conv_s4d__dense_activation_silu__prompt_kernel
.p2align 8
.type recurrent_scan__ssm_conv_s4d__dense_activation_silu__prompt_kernel,@function
recurrent_scan__ssm_conv_s4d__dense_activation_silu__prompt_kernel:
    s_cmp_ge_u32 s2, 256
    s_cbranch_scc1 L_end
    s_load_dwordx16 s[16:31], s[0:1], 0
    s_load_dwordx8 s[32:39], s[0:1], 64
    s_load_dwordx2 s[40:41], s[0:1], 96
    s_getpc_b64 s[64:65]
L_pc:
    s_and_b32 s65, s65, 0xffff
    s_mov_b32 s66, L_code_end-L_pc
    s_mov_b32 s67, 0x00020000
    v_lshlrev_b32 v1, 7, v0
    buffer_load_dword v254, v1, s[64:67], 0 offen
    v_lshrrev_b32 v1, 6, v0
    v_and_b32 v0, 63, v0
    v_readfirstlane_b32 s3, v1
    v_lshlrev_b32 v1, 4, v0
    s_and_b32 s81, s2, 7
    s_lshr_b32 s82, s2, 3
    s_lshr_b32 s42, s81, 1
    s_lshl_b32 s42, s42, 3
    s_and_b32 s4, s82, 7
    s_add_u32 s4, s4, s42
    s_and_b32 s42, s81, 1
    s_lshl_b32 s42, s42, 2
    s_lshr_b32 s5, s82, 3
    s_add_u32 s5, s5, s42
    v_mov_b32 v2, 161280
    s_cmp_ge_u32 s3, 4
    s_cbranch_scc1 L_conv
    v_lshrrev_b32 v14, 4, v0
    v_and_b32 v14, 2, v14
    v_xor_b32 v14, v14, v0
    v_and_b32 v14, 3, v14
    v_lshrrev_b32 v15, 2, v0
    v_mul_u32_u24 v4, 2752, v15
    v_lshl_add_u32 v4, v14, 4, v4
    v_add_u32 v5, 43008, v4
    v_bfe_u32 v14, v0, 1, 2
    v_lshrrev_b32 v15, 5, v0
    v_lshl_add_u32 v14, v15, 2, v14
    v_bfe_u32 v15, v0, 3, 2
    v_lshl_add_u32 v14, v15, 3, v14
    v_mul_u32_u24 v14, 2752, v14
    v_and_b32 v15, 1, v0
    v_lshl_add_u32 v6, v15, 4, v14
    s_mul_i32 s42, s5, 43
    s_add_u32 s43, s42, 35
    s_lshr_b32 s42, s42, 3
    s_lshr_b32 s43, s43, 3
    s_sub_u32 s43, s43, s42
    s_lshl_b32 s68, s3, 3
    s_lshr_b32 s68, 0x05030200, s68
    s_and_b32 s68, s68, 7
    s_min_u32 s68, s68, s43
    s_add_u32 s0, s42, s68
    s_lshl_b32 s10, s0, 6
    s_lshr_b32 s68, s3, 1
    s_mul_i32 s68, s68, 3
    s_add_u32 s68, s68, 1
    s_add_u32 s1, s42, s68
    s_cmp_lt_u32 s68, s43
    s_cselect_b32 s9, 0, 1073741824
    s_lshl_b32 s13, s1, 1
    s_and_b32 s68, s3, 1
    s_add_u32 s13, s13, s68
    s_lshl_b32 s13, s13, 5
    s_add_u32 s13, s13, s9
    s_and_b32 s42, s82, 7
    s_mul_i32 s11, s42, 176128
    s_lshl_b32 s6, s42, 7
    s_mul_i32 s12, s3, 9216
    s_add_u32 s12, s12, 65536
    v_and_b32 v14, 15, v0
    v_lshrrev_b32 v137, 4, v0
    v_xor_b32 v15, v14, v137
    v_and_b32 v15, 3, v15
    v_lshlrev_b32 v15, 4, v15
    v_lshl_add_u32 v15, v14, 10, v15
    v_lshrrev_b32 v14, 2, v14
    v_lshl_add_u32 v7, v14, 6, v15
    v_lshl_add_u32 v15, v137, 3, v14
    v_lshlrev_b32 v15, 6, v15
    v_and_b32 v8, 1, v137
    v_lshl_add_u32 v15, v8, 5, v15
    v_and_b32 v8, 3, v0
    v_lshl_add_u32 v15, v8, 3, v15
    v_add_u32 v8, s12, v15
    v_xor_b32 v9, 32, v8
    v_lshlrev_b32 v10, 3, v0
    v_add_u32 v10, s12, v10
    v_mov_b32 v132, 0x3f803f80
    v_mov_b32 v133, 0x3f803f80
    v_mov_b32 v134, 0x3f803f80
    v_mov_b32 v135, 0x3f803f80
    s_lshl_b32 s15, s3, 14
    s_lshl_b32 s73, s4, 16
    s_lshl_b32 s72, s5, 12
    s_add_u32 s43, s5, 0
    s_and_b32 s43, s43, 3
    s_lshl_b32 s69, s43, 6
    v_xor_b32 v160, s69, v1
    v_xor_b32 v161, 16, v160
    v_xor_b32 v162, 32, v160
    v_xor_b32 v163, 48, v160
    s_lshl_b32 s43, s43, 12
    s_add_u32 s74, s43, s15
    s_add_u32 s43, s5, 1
    s_and_b32 s43, s43, 3
    s_lshl_b32 s69, s43, 6
    v_xor_b32 v164, s69, v1
    v_xor_b32 v165, 16, v164
    v_xor_b32 v166, 32, v164
    v_xor_b32 v167, 48, v164
    s_lshl_b32 s43, s43, 12
    s_add_u32 s75, s43, s15
    s_add_u32 s43, s5, 2
    s_and_b32 s43, s43, 3
    s_lshl_b32 s69, s43, 6
    v_xor_b32 v168, s69, v1
    v_xor_b32 v169, 16, v168
    v_xor_b32 v170, 32, v168
    v_xor_b32 v171, 48, v168
    s_lshl_b32 s43, s43, 12
    s_add_u32 s76, s43, s15
    s_add_u32 s43, s5, 3
    s_and_b32 s43, s43, 3
    s_lshl_b32 s69, s43, 6
    v_xor_b32 v172, s69, v1
    v_xor_b32 v173, 16, v172
    v_xor_b32 v174, 32, v172
    v_xor_b32 v175, 48, v172
    s_lshl_b32 s43, s43, 12
    s_add_u32 s77, s43, s15
    s_mov_b32 s46, 2097152
    s_mov_b32 s47, 0x00020000
    s_mov_b32 s50, 1409024
    s_mov_b32 s51, 0x00020000
    s_waitcnt lgkmcnt(0)
    s_barrier
    s_mov_b32 s44, s16
    s_and_b32 s45, s17, 0xffff
    s_mov_b32 s48, s32
    s_and_b32 s49, s33, 0xffff
    s_mov_b32 m0, s74
    s_add_u32 s43, s74, s73
    buffer_load_dwordx4 v160, s[44:47], s43 offen offset:0 lds
    buffer_load_dwordx4 v161, s[44:47], s43 offen offset:1024 lds
    buffer_load_dwordx4 v162, s[44:47], s43 offen offset:2048 lds
    buffer_load_dwordx4 v163, s[44:47], s43 offen offset:3072 lds
    s_mov_b32 m0, s75
    s_add_u32 s43, s75, s73
    buffer_load_dwordx4 v164, s[44:47], s43 offen offset:0 lds
    buffer_load_dwordx4 v165, s[44:47], s43 offen offset:1024 lds
    buffer_load_dwordx4 v166, s[44:47], s43 offen offset:2048 lds
    buffer_load_dwordx4 v167, s[44:47], s43 offen offset:3072 lds
    s_setprio 3
    s_mov_b32 s60, s40
    s_and_b32 s61, s41, 0xffff
    s_mov_b32 s62, 268435456
    s_mov_b32 s63, 0x00020000
    v_add_u32 v32, s15, v7
    v_xor_b32 v33, 64, v32
    v_xor_b32 v34, 128, v32
    v_xor_b32 v35, 192, v32
    s_lshl_b32 s43, s5, 3
    v_add_u32 v43, s43, v137
    v_and_b32 v45, 1, v0
    v_lshlrev_b32 v45, 3, v45
    v_bfe_u32 v46, v0, 2, 2
    v_add_u32 v45, v45, v46
    v_bfe_u32 v46, v0, 1, 1
    v_lshl_add_u32 v46, v46, 3, s15
    v_xor_b32 v44, v45, v43
    v_lshl_add_u32 v44, v44, 4, v46
    v_lshl_add_u32 v36, v45, 10, v44
    v_xor_b32 v38, 64, v36
    v_add_u32 v45, 4, v45
    v_xor_b32 v44, v45, v43
    v_lshl_add_u32 v44, v44, 4, v46
    v_lshl_add_u32 v37, v45, 10, v44
    v_xor_b32 v39, 64, v37
    v_lshrrev_b32 v45, 3, v0
    v_lshlrev_b32 v45, 14, v45
    v_and_b32 v46, 0x70, v1
    v_add_u32 v40, v45, v46
    v_bfe_u32 v45, v0, 2, 1
    s_lshl_b32 s42, s3, 7
    s_add_u32 s42, s42, 161536
    v_lshl_add_u32 v41, v45, 6, s42
    v_and_b32 v42, 15, v0
    v_lshl_add_u32 v44, v42, 3, s42
    v_and_b32 v43, 3, v0
    v_lshrrev_b32 v42, 2, v42
    s_lshl_b32 s42, s4, 2
    s_add_u32 s42, s42, s3
    s_lshl_b32 s43, s5, 18
    s_lshl_b32 s68, s42, 7
    s_add_u32 s43, s43, s68
    s_add_u32 s26, s43, 131072
    s_add_u32 s27, s26, 131072
    s_lshl_b32 s43, s5, 7
    s_add_u32 s42, s42, s43
    s_lshl_b32 s42, s42, 4
    s_add_u32 s30, s42, 4096
    v_mov_b32 v14, 1
    s_lshl_b32 s42, s3, 2
    v_add_u32 v140, s42, v2
    s_setprio 0
    s_mov_b32 m0, s76
    s_add_u32 s43, s76, s73
    buffer_load_dwordx4 v168, s[44:47], s43 offen offset:0 lds
    buffer_load_dwordx4 v169, s[44:47], s43 offen offset:1024 lds
    buffer_load_dwordx4 v170, s[44:47], s43 offen offset:2048 lds
    buffer_load_dwordx4 v171, s[44:47], s43 offen offset:3072 lds
    s_mov_b32 m0, s77
    s_add_u32 s43, s77, s73
    buffer_load_dwordx4 v172, s[44:47], s43 offen offset:0 lds
    buffer_load_dwordx4 v173, s[44:47], s43 offen offset:1024 lds
    buffer_load_dwordx4 v174, s[44:47], s43 offen offset:2048 lds
    buffer_load_dwordx4 v175, s[44:47], s43 offen offset:3072 lds
    s_add_u32 m0, s12, 0
    s_add_u32 s43, s10, s11
    buffer_load_dwordx4 v4, s[48:51], s43 offen lds
    s_add_u32 s68, s13, s11
    buffer_load_dwordx4 v5, s[48:51], s43 offen offset:1024 lds
    s_add_u32 m0, s12, 2048
    s_add_u32 s11, s11, 88064
    buffer_load_dwordx4 v6, s[48:51], s68 offen lds
    s_cmp_eq_u32 s11, 1409024
    s_cselect_b32 s11, 0, s11
    s_add_u32 m0, s12, 3072
    s_add_u32 s43, s10, s11
    buffer_load_dwordx4 v4, s[48:51], s43 offen lds
    s_add_u32 s68, s13, s11
    buffer_load_dwordx4 v5, s[48:51], s43 offen offset:1024 lds
    s_add_u32 m0, s12, 5120
    s_add_u32 s11, s11, 88064
    buffer_load_dwordx4 v6, s[48:51], s68 offen lds
    s_cmp_eq_u32 s11, 1409024
    s_cselect_b32 s11, 0, s11
    s_add_u32 m0, s12, 6144
    s_add_u32 s43, s10, s11
    buffer_load_dwordx4 v4, s[48:51], s43 offen lds
    s_add_u32 s68, s13, s11
    buffer_load_dwordx4 v5, s[48:51], s43 offen offset:1024 lds
    s_add_u32 m0, s12, 8192
    s_add_u32 s11, s11, 88064
    buffer_load_dwordx4 v6, s[48:51], s68 offen lds
    s_cmp_eq_u32 s11, 1409024
    s_cselect_b32 s11, 0, s11
    s_setprio 3
    s_waitcnt vmcnt(9)
    ds_read_b128 v[176:179], v32 offset:0
    ds_read_b128 v[180:183], v33 offset:0
    ds_read_b128 v[184:187], v34 offset:0
    ds_read_b128 v[188:191], v35 offset:0
    ds_read_b128 v[192:195], v32 offset:256
    ds_read_b128 v[196:199], v33 offset:256
    ds_read_b128 v[200:203], v34 offset:256
    ds_read_b128 v[204:207], v35 offset:256
    ds_read_b128 v[208:211], v32 offset:512
    ds_read_b128 v[212:215], v33 offset:512
    ds_read_b128 v[216:219], v34 offset:512
    ds_read_b128 v[220:223], v35 offset:512
    ds_read_b128 v[224:227], v32 offset:768
    ds_read_b128 v[228:231], v33 offset:768
    ds_read_b128 v[232:235], v34 offset:768
    ds_read_b128 v[236:239], v35 offset:768
    s_waitcnt lgkmcnt(12)
    v_mfma_f32_16x16x32_bf16 v[240:243], v[176:179], v[132:135], 0
    v_mfma_f32_16x16x32_bf16 v[244:247], v[176:179], v[176:179], 0
    v_mfma_f32_16x16x32_bf16 v[240:243], v[180:183], v[132:135], v[240:243]
    v_mfma_f32_16x16x32_bf16 v[244:247], v[180:183], v[180:183], v[244:247]
    v_mfma_f32_16x16x32_bf16 v[240:243], v[184:187], v[132:135], v[240:243]
    v_mfma_f32_16x16x32_bf16 v[244:247], v[184:187], v[184:187], v[244:247]
    v_mfma_f32_16x16x32_bf16 v[240:243], v[188:191], v[132:135], v[240:243]
    v_mfma_f32_16x16x32_bf16 v[244:247], v[188:191], v[188:191], v[244:247]
    s_waitcnt lgkmcnt(8)
    v_mfma_f32_16x16x32_bf16 v[240:243], v[192:195], v[132:135], v[240:243]
    v_mfma_f32_16x16x32_bf16 v[244:247], v[192:195], v[192:195], v[244:247]
    v_mfma_f32_16x16x32_bf16 v[240:243], v[196:199], v[132:135], v[240:243]
    v_mfma_f32_16x16x32_bf16 v[244:247], v[196:199], v[196:199], v[244:247]
    v_mfma_f32_16x16x32_bf16 v[240:243], v[200:203], v[132:135], v[240:243]
    v_mfma_f32_16x16x32_bf16 v[244:247], v[200:203], v[200:203], v[244:247]
    v_mfma_f32_16x16x32_bf16 v[240:243], v[204:207], v[132:135], v[240:243]
    v_mfma_f32_16x16x32_bf16 v[244:247], v[204:207], v[204:207], v[244:247]
    s_waitcnt lgkmcnt(4)
    v_mfma_f32_16x16x32_bf16 v[240:243], v[208:211], v[132:135], v[240:243]
    v_mfma_f32_16x16x32_bf16 v[244:247], v[208:211], v[208:211], v[244:247]
    v_mfma_f32_16x16x32_bf16 v[240:243], v[212:215], v[132:135], v[240:243]
    v_mfma_f32_16x16x32_bf16 v[244:247], v[212:215], v[212:215], v[244:247]
    v_mfma_f32_16x16x32_bf16 v[240:243], v[216:219], v[132:135], v[240:243]
    v_mfma_f32_16x16x32_bf16 v[244:247], v[216:219], v[216:219], v[244:247]
    v_mfma_f32_16x16x32_bf16 v[240:243], v[220:223], v[132:135], v[240:243]
    v_mfma_f32_16x16x32_bf16 v[244:247], v[220:223], v[220:223], v[244:247]
    s_waitcnt lgkmcnt(0)
    v_mfma_f32_16x16x32_bf16 v[240:243], v[224:227], v[132:135], v[240:243]
    v_mfma_f32_16x16x32_bf16 v[244:247], v[224:227], v[224:227], v[244:247]
    v_mfma_f32_16x16x32_bf16 v[240:243], v[228:231], v[132:135], v[240:243]
    v_mfma_f32_16x16x32_bf16 v[244:247], v[228:231], v[228:231], v[244:247]
    v_mfma_f32_16x16x32_bf16 v[240:243], v[232:235], v[132:135], v[240:243]
    v_mfma_f32_16x16x32_bf16 v[244:247], v[232:235], v[232:235], v[244:247]
    v_mfma_f32_16x16x32_bf16 v[240:243], v[236:239], v[132:135], v[240:243]
    v_mfma_f32_16x16x32_bf16 v[244:247], v[236:239], v[236:239], v[244:247]
    ds_read_b64_tr_b16 v[248:249], v36
    ds_read_b64_tr_b16 v[250:251], v37
    ds_read_b64_tr_b16 v[252:253], v38
    ds_read_b64_tr_b16 v[254:255], v39
    v_cmp_eq_u32 vcc, 1, v43
    s_nop 1
    v_cndmask_b32 v240, v240, v241, vcc
    v_cndmask_b32 v244, v244, v245, vcc
    v_cmp_eq_u32 vcc, 2, v43
    s_nop 1
    v_cndmask_b32 v240, v240, v242, vcc
    v_cndmask_b32 v244, v244, v246, vcc
    v_cmp_eq_u32 vcc, 3, v43
    s_nop 1
    v_cndmask_b32 v240, v240, v243, vcc
    v_cndmask_b32 v244, v244, v247, vcc
    v_mul_f32 v240, 0x3b000000, v240
    v_mul_f32 v244, 0x3b000000, v244
    v_fma_f32 v244, -v240, v240, v244
    v_max_f32 v244, 0, v244
    v_cvt_pk_bf16_f32 v240, v240, v244
    v_and_b32 v244, 0xffff0000, v240
    v_add_f32 v244, 0x3727c5ac, v244
    v_cvt_pk_bf16_f32 v244, v244, v244
    v_lshlrev_b32 v244, 16, v244
    v_sqrt_f32 v244, v244
    v_lshlrev_b32 v240, 16, v240
    v_cvt_pk_bf16_f32 v244, v244, v244
    v_lshlrev_b32 v244, 16, v244
    v_rcp_f32 v242, v244
    v_cmp_eq_u32 vcc, v42, v137
    v_mul_f32 v243, v240, v242
    v_mul_f32 v245, 0xbfb8aa3b, v242
    v_mov_b32 v241, v244
    s_and_saveexec_b64 s[28:29], vcc
    ds_write_b64 v44, v[242:243]
    ds_write_b64 v44, v[240:241] offset:512
    ds_write_b32 v44, v245 offset:1024
    s_mov_b64 exec, 1
    ds_add_u32 v2, v14 offset:12
    s_mov_b64 exec, -1
    ds_read_b128 v[176:179], v41 offset:0
    ds_read_b128 v[180:183], v41 offset:16
    ds_read_b128 v[184:187], v41 offset:32
    ds_read_b128 v[188:191], v41 offset:48
    s_waitcnt lgkmcnt(8)
    v_lshlrev_b32 v16, 16, v248
    v_and_b32 v17, 0xffff0000, v248
    v_lshlrev_b32 v18, 16, v249
    v_and_b32 v19, 0xffff0000, v249
    v_lshlrev_b32 v20, 16, v250
    v_and_b32 v21, 0xffff0000, v250
    v_lshlrev_b32 v22, 16, v251
    v_and_b32 v23, 0xffff0000, v251
    v_lshlrev_b32 v24, 16, v252
    v_and_b32 v25, 0xffff0000, v252
    v_lshlrev_b32 v26, 16, v253
    v_and_b32 v27, 0xffff0000, v253
    v_lshlrev_b32 v28, 16, v254
    v_and_b32 v29, 0xffff0000, v254
    v_lshlrev_b32 v30, 16, v255
    v_and_b32 v31, 0xffff0000, v255
    s_waitcnt lgkmcnt(0)
    v_fma_f32 v16, v16, v176, -v177
    v_fma_f32 v17, v17, v178, -v179
    v_fma_f32 v18, v18, v180, -v181
    v_fma_f32 v19, v19, v182, -v183
    v_fma_f32 v20, v20, v184, -v185
    v_fma_f32 v21, v21, v186, -v187
    v_fma_f32 v22, v22, v188, -v189
    v_fma_f32 v23, v23, v190, -v191
    v_cvt_pk_bf16_f32 v248, v16, v17
    v_cvt_pk_bf16_f32 v249, v18, v19
    v_cvt_pk_bf16_f32 v250, v20, v21
    v_cvt_pk_bf16_f32 v251, v22, v23
    buffer_store_dwordx4 v[248:251], v40, s[60:63], s26 offen sc1
    v_fma_f32 v24, v24, v176, -v177
    v_fma_f32 v25, v25, v178, -v179
    v_fma_f32 v26, v26, v180, -v181
    v_fma_f32 v27, v27, v182, -v183
    v_fma_f32 v28, v28, v184, -v185
    v_fma_f32 v29, v29, v186, -v187
    v_fma_f32 v30, v30, v188, -v189
    v_fma_f32 v31, v31, v190, -v191
    v_cvt_pk_bf16_f32 v252, v24, v25
    v_cvt_pk_bf16_f32 v253, v26, v27
    v_cvt_pk_bf16_f32 v254, v28, v29
    v_cvt_pk_bf16_f32 v255, v30, v31
    buffer_store_dwordx4 v[252:255], v40, s[60:63], s27 offen sc1
    s_mov_b32 s83, 0
LW_1:
    ds_read_b32 v15, v2 offset:12
    s_add_u32 s83, s83, 1
    s_waitcnt lgkmcnt(0)
    v_readfirstlane_b32 s42, v15
    s_cmp_gt_u32 s83, 2097152
    s_cbranch_scc1 LWD_2
    s_cmp_ge_u32 s42, 4
    s_cbranch_scc1 LWD_2
    s_sleep 1
    s_branch LW_1
LWD_2:
    s_setprio 1
    s_waitcnt vmcnt(8)
    v_xor_b32 v136, s6, v7
    ds_read_b64_tr_b16 v[76:77], v8 offset:0
    ds_read_b64_tr_b16 v[78:79], v8 offset:256
    ds_read_b128 v[88:91], v136
    ds_read_b128 v[92:95], v136 offset:16384
    ds_read_b64_tr_b16 v[80:81], v9 offset:0
    ds_read_b64_tr_b16 v[82:83], v9 offset:256
    ds_read_b128 v[96:99], v136 offset:32768
    ds_read_b128 v[100:103], v136 offset:49152
    s_add_u32 s6, s6, 64
    s_and_b32 s6, s6, 0x3c0
    ds_read_b64_tr_b16 v[84:85], v10 offset:2048
    ds_read_b64_tr_b16 v[86:87], v10 offset:2560
    s_waitcnt lgkmcnt(0)
    v_mfma_f32_16x16x32_bf16 v[16:19], v[76:79], v[88:91], 0
    s_add_u32 m0, s12, 0
    s_add_u32 s43, s10, s11
    buffer_load_dwordx4 v4, s[48:51], s43 offen lds
    v_mfma_f32_16x16x32_bf16 v[20:23], v[76:79], v[92:95], 0
    s_add_u32 s68, s13, s11
    buffer_load_dwordx4 v5, s[48:51], s43 offen offset:1024 lds
    v_mfma_f32_16x16x32_bf16 v[24:27], v[76:79], v[96:99], 0
    s_add_u32 m0, s12, 2048
    s_add_u32 s11, s11, 88064
    buffer_load_dwordx4 v6, s[48:51], s68 offen lds
    s_cmp_eq_u32 s11, 1409024
    s_cselect_b32 s11, 0, s11
    s_waitcnt vmcnt(8)
    v_mfma_f32_16x16x32_bf16 v[28:31], v[76:79], v[100:103], 0
    v_xor_b32 v136, s6, v7
    ds_read_b64_tr_b16 v[104:105], v8 offset:3072
    v_mfma_f32_16x16x32_bf16 v[64:67], v[76:79], v[132:135], 0
    ds_read_b64_tr_b16 v[106:107], v8 offset:3328
    v_mfma_f32_16x16x32_bf16 v[32:35], v[80:83], v[88:91], 0
    ds_read_b128 v[116:119], v136
    v_mfma_f32_16x16x32_bf16 v[36:39], v[80:83], v[92:95], 0
    ds_read_b128 v[120:123], v136 offset:16384
    v_mfma_f32_16x16x32_bf16 v[40:43], v[80:83], v[96:99], 0
    ds_read_b64_tr_b16 v[108:109], v9 offset:3072
    v_mfma_f32_16x16x32_bf16 v[44:47], v[80:83], v[100:103], 0
    ds_read_b64_tr_b16 v[110:111], v9 offset:3328
    v_mfma_f32_16x16x32_bf16 v[68:71], v[80:83], v[132:135], 0
    ds_read_b128 v[124:127], v136 offset:32768
    v_mfma_f32_16x16x32_bf16 v[48:51], v[84:87], v[88:91], 0
    ds_read_b128 v[128:131], v136 offset:49152
    s_add_u32 s6, s6, 64
    s_and_b32 s6, s6, 0x3c0
    v_mfma_f32_16x16x32_bf16 v[52:55], v[84:87], v[92:95], 0
    ds_read_b64_tr_b16 v[112:113], v10 offset:5120
    v_mfma_f32_16x16x32_bf16 v[56:59], v[84:87], v[96:99], 0
    ds_read_b64_tr_b16 v[114:115], v10 offset:5632
    v_mfma_f32_16x16x32_bf16 v[60:63], v[84:87], v[100:103], 0
    v_mfma_f32_16x16x32_bf16 v[72:75], v[84:87], v[132:135], 0
    s_waitcnt lgkmcnt(0)
    v_mfma_f32_16x16x32_bf16 v[16:19], v[104:107], v[116:119], v[16:19]
    s_add_u32 m0, s12, 3072
    s_add_u32 s43, s10, s11
    buffer_load_dwordx4 v4, s[48:51], s43 offen lds
    v_mfma_f32_16x16x32_bf16 v[20:23], v[104:107], v[120:123], v[20:23]
    s_add_u32 s68, s13, s11
    buffer_load_dwordx4 v5, s[48:51], s43 offen offset:1024 lds
    v_mfma_f32_16x16x32_bf16 v[24:27], v[104:107], v[124:127], v[24:27]
    s_add_u32 m0, s12, 5120
    s_add_u32 s11, s11, 88064
    buffer_load_dwordx4 v6, s[48:51], s68 offen lds
    s_cmp_eq_u32 s11, 1409024
    s_cselect_b32 s11, 0, s11
    s_waitcnt vmcnt(8)
    v_mfma_f32_16x16x32_bf16 v[28:31], v[104:107], v[128:131], v[28:31]
    v_xor_b32 v136, s6, v7
    ds_read_b64_tr_b16 v[76:77], v8 offset:6144
    s_mov_b32 s29, s0
    v_mfma_f32_16x16x32_bf16 v[64:67], v[104:107], v[132:135], v[64:67]
    ds_read_b64_tr_b16 v[78:79], v8 offset:6400
    s_mov_b32 s64, s38
    v_mfma_f32_16x16x32_bf16 v[32:35], v[108:111], v[116:119], v[32:35]
    ds_read_b128 v[88:91], v136
    s_and_b32 s65, s39, 0xffff
    v_mfma_f32_16x16x32_bf16 v[36:39], v[108:111], v[120:123], v[36:39]
    ds_read_b128 v[92:95], v136 offset:16384
    s_mov_b32 s66, 256
    v_mfma_f32_16x16x32_bf16 v[40:43], v[108:111], v[124:127], v[40:43]
    ds_read_b64_tr_b16 v[80:81], v9 offset:6144
    s_mov_b32 s67, 0x00020000
    v_mfma_f32_16x16x32_bf16 v[44:47], v[108:111], v[128:131], v[44:47]
    ds_read_b64_tr_b16 v[82:83], v9 offset:6400
    s_mov_b32 s52, s34
    v_mfma_f32_16x16x32_bf16 v[68:71], v[108:111], v[132:135], v[68:71]
    ds_read_b128 v[96:99], v136 offset:32768
    s_and_b32 s53, s35, 0xffff
    v_mfma_f32_16x16x32_bf16 v[48:51], v[112:115], v[116:119], v[48:51]
    ds_read_b128 v[100:103], v136 offset:49152
    s_add_u32 s6, s6, 64
    s_and_b32 s6, s6, 0x3c0
    s_mov_b32 s54, 1409024
    v_mfma_f32_16x16x32_bf16 v[52:55], v[112:115], v[120:123], v[52:55]
    ds_read_b64_tr_b16 v[84:85], v10 offset:8192
    s_mov_b32 s55, 0x00020000
    v_mfma_f32_16x16x32_bf16 v[56:59], v[112:115], v[124:127], v[56:59]
    ds_read_b64_tr_b16 v[86:87], v10 offset:8704
    s_mov_b32 s56, s36
    v_mfma_f32_16x16x32_bf16 v[60:63], v[112:115], v[128:131], v[60:63]
    s_and_b32 s57, s37, 0xffff
    v_mfma_f32_16x16x32_bf16 v[72:75], v[112:115], v[132:135], v[72:75]
    s_mov_b32 s58, 2097152
    s_waitcnt lgkmcnt(0)
    v_mfma_f32_16x16x32_bf16 v[16:19], v[76:79], v[88:91], v[16:19]
    s_add_u32 m0, s12, 6144
    s_add_u32 s43, s10, s11
    buffer_load_dwordx4 v4, s[48:51], s43 offen lds
    v_mfma_f32_16x16x32_bf16 v[20:23], v[76:79], v[92:95], v[20:23]
    s_add_u32 s68, s13, s11
    buffer_load_dwordx4 v5, s[48:51], s43 offen offset:1024 lds
    v_mfma_f32_16x16x32_bf16 v[24:27], v[76:79], v[96:99], v[24:27]
    s_add_u32 m0, s12, 8192
    s_add_u32 s11, s11, 88064
    buffer_load_dwordx4 v6, s[48:51], s68 offen lds
    s_cmp_eq_u32 s11, 1409024
    s_cselect_b32 s11, 0, s11
    ds_read_b32 v159, v140 offset:128
    s_waitcnt vmcnt(6)
    v_mfma_f32_16x16x32_bf16 v[28:31], v[76:79], v[100:103], v[28:31]
    v_xor_b32 v136, s6, v7
    ds_read_b64_tr_b16 v[104:105], v8 offset:0
    s_mov_b32 s59, 0x00020000
    v_mfma_f32_16x16x32_bf16 v[64:67], v[76:79], v[132:135], v[64:67]
    ds_read_b64_tr_b16 v[106:107], v8 offset:256
    s_mov_b32 s7, s5
    v_mfma_f32_16x16x32_bf16 v[32:35], v[80:83], v[88:91], v[32:35]
    ds_read_b128 v[116:119], v136
    s_mul_i32 s34, s4, 43
    v_mfma_f32_16x16x32_bf16 v[36:39], v[80:83], v[92:95], v[36:39]
    ds_read_b128 v[120:123], v136 offset:16384
    s_add_u32 s0, s0, s34
    v_mfma_f32_16x16x32_bf16 v[40:43], v[80:83], v[96:99], v[40:43]
    ds_read_b64_tr_b16 v[108:109], v9 offset:0
    s_lshl_b32 s0, s0, 12
    v_mfma_f32_16x16x32_bf16 v[44:47], v[80:83], v[100:103], v[44:47]
    ds_read_b64_tr_b16 v[110:111], v9 offset:256
    s_add_u32 s0, s0, 4325376
    v_mfma_f32_16x16x32_bf16 v[68:71], v[80:83], v[132:135], v[68:71]
    ds_read_b128 v[124:127], v136 offset:32768
    s_add_u32 s1, s1, s34
    v_mfma_f32_16x16x32_bf16 v[48:51], v[84:87], v[88:91], v[48:51]
    ds_read_b128 v[128:131], v136 offset:49152
    s_add_u32 s6, s6, 64
    s_and_b32 s6, s6, 0x3c0
    s_lshl_b32 s1, s1, 12
    v_mfma_f32_16x16x32_bf16 v[52:55], v[84:87], v[92:95], v[52:55]
    ds_read_b64_tr_b16 v[112:113], v10 offset:2048
    s_add_u32 s1, s1, s9
    v_mfma_f32_16x16x32_bf16 v[56:59], v[84:87], v[96:99], v[56:59]
    ds_read_b64_tr_b16 v[114:115], v10 offset:2560
    s_and_b32 s35, s3, 1
    v_mfma_f32_16x16x32_bf16 v[60:63], v[84:87], v[100:103], v[60:63]
    s_lshl_b32 s35, s35, 11
    v_mfma_f32_16x16x32_bf16 v[72:75], v[84:87], v[132:135], v[72:75]
    s_add_u32 s35, s35, 4325376
    s_waitcnt lgkmcnt(0)
    v_mfma_f32_16x16x32_bf16 v[16:19], v[104:107], v[116:119], v[16:19]
    s_add_u32 m0, s12, 0
    s_add_u32 s43, s10, s11
    buffer_load_dwordx4 v4, s[48:51], s43 offen lds
    v_mfma_f32_16x16x32_bf16 v[20:23], v[104:107], v[120:123], v[20:23]
    s_add_u32 s68, s13, s11
    buffer_load_dwordx4 v5, s[48:51], s43 offen offset:1024 lds
    v_mfma_f32_16x16x32_bf16 v[24:27], v[104:107], v[124:127], v[24:27]
    s_add_u32 m0, s12, 2048
    s_add_u32 s11, s11, 88064
    buffer_load_dwordx4 v6, s[48:51], s68 offen lds
    s_cmp_eq_u32 s11, 1409024
    s_cselect_b32 s11, 0, s11
    v_readfirstlane_b32 s8, v159
    s_cmp_lg_u32 s8, 0
    s_cbranch_scc1 TOK_3
    s_mov_b32 s83, 0
LW_4:
    ds_read_b32 v159, v140 offset:128
    s_add_u32 s83, s83, 1
    s_waitcnt lgkmcnt(0)
    v_readfirstlane_b32 s42, v159
    s_cmp_gt_u32 s83, 2097152
    s_cbranch_scc1 LWD_5
    s_cmp_ge_u32 s42, 1
    s_cbranch_scc1 LWD_5
    s_sleep 1
    s_branch LW_4
LWD_5:
    s_mov_b32 s8, s42
TOK_3:
    v_mov_b32 v15, 0
    v_mov_b32 v159, s8
    s_mov_b64 exec, 1
    buffer_store_dword v159, v15, s[60:63], s30 offen sc1
    s_mov_b64 exec, -1
    s_waitcnt vmcnt(7)
    v_mfma_f32_16x16x32_bf16 v[28:31], v[104:107], v[128:131], v[28:31]
    v_xor_b32 v136, s6, v7
    ds_read_b64_tr_b16 v[76:77], v8 offset:3072
    s_add_u32 s1, s1, s35
    v_mfma_f32_16x16x32_bf16 v[64:67], v[104:107], v[132:135], v[64:67]
    ds_read_b64_tr_b16 v[78:79], v8 offset:3328
    s_lshl_b32 s34, s4, 3
    v_mfma_f32_16x16x32_bf16 v[32:35], v[108:111], v[116:119], v[32:35]
    ds_read_b128 v[88:91], v136
    s_add_u32 s34, s34, s5
    v_mfma_f32_16x16x32_bf16 v[36:39], v[108:111], v[120:123], v[36:39]
    ds_read_b128 v[92:95], v136 offset:16384
    s_lshl_b32 s34, s34, 2
    v_mfma_f32_16x16x32_bf16 v[40:43], v[108:111], v[124:127], v[40:43]
    ds_read_b64_tr_b16 v[80:81], v9 offset:3072
    s_add_u32 s34, s34, s3
    v_mfma_f32_16x16x32_bf16 v[44:47], v[108:111], v[128:131], v[44:47]
    ds_read_b64_tr_b16 v[82:83], v9 offset:3328
    s_lshl_b32 s34, s34, 4
    v_mfma_f32_16x16x32_bf16 v[68:71], v[108:111], v[132:135], v[68:71]
    ds_read_b128 v[96:99], v136 offset:32768
    s_add_u32 s14, s34, 36864
    v_mfma_f32_16x16x32_bf16 v[48:51], v[112:115], v[116:119], v[48:51]
    ds_read_b128 v[100:103], v136 offset:49152
    s_add_u32 s6, s6, 64
    s_and_b32 s6, s6, 0x3c0
    v_bfe_u32 v138, v0, 2, 2
    v_mfma_f32_16x16x32_bf16 v[52:55], v[112:115], v[120:123], v[52:55]
    ds_read_b64_tr_b16 v[84:85], v10 offset:5120
    v_lshl_add_u32 v12, v137, 2, v138
    v_mfma_f32_16x16x32_bf16 v[56:59], v[112:115], v[124:127], v[56:59]
    ds_read_b64_tr_b16 v[86:87], v10 offset:5632
    v_lshlrev_b32 v12, 7, v12
    v_mfma_f32_16x16x32_bf16 v[60:63], v[112:115], v[128:131], v[60:63]
    v_lshrrev_b32 v138, 1, v138
    v_mfma_f32_16x16x32_bf16 v[72:75], v[112:115], v[132:135], v[72:75]
    v_lshl_add_u32 v12, v138, 6, v12
    s_waitcnt lgkmcnt(0)
    v_mfma_f32_16x16x32_bf16 v[16:19], v[76:79], v[88:91], v[16:19]
    s_add_u32 m0, s12, 3072
    s_add_u32 s43, s10, s11
    buffer_load_dwordx4 v4, s[48:51], s43 offen lds
    v_mfma_f32_16x16x32_bf16 v[20:23], v[76:79], v[92:95], v[20:23]
    s_add_u32 s68, s13, s11
    buffer_load_dwordx4 v5, s[48:51], s43 offen offset:1024 lds
    v_mfma_f32_16x16x32_bf16 v[24:27], v[76:79], v[96:99], v[24:27]
    s_add_u32 m0, s12, 5120
    s_add_u32 s11, s11, 88064
    buffer_load_dwordx4 v6, s[48:51], s68 offen lds
    s_cmp_eq_u32 s11, 1409024
    s_cselect_b32 s11, 0, s11
    s_waitcnt vmcnt(7)
    v_mfma_f32_16x16x32_bf16 v[28:31], v[76:79], v[100:103], v[28:31]
    v_xor_b32 v136, s6, v7
    ds_read_b64_tr_b16 v[104:105], v8 offset:6144
    v_and_b32 v138, 3, v0
    v_mfma_f32_16x16x32_bf16 v[64:67], v[76:79], v[132:135], v[64:67]
    ds_read_b64_tr_b16 v[106:107], v8 offset:6400
    v_lshl_add_u32 v12, v138, 4, v12
    v_mfma_f32_16x16x32_bf16 v[32:35], v[80:83], v[88:91], v[32:35]
    ds_read_b128 v[116:119], v136
    v_add_u32 v3, s12, v12
    v_mfma_f32_16x16x32_bf16 v[36:39], v[80:83], v[92:95], v[36:39]
    ds_read_b128 v[120:123], v136 offset:16384
    v_add_u32 v12, s15, v12
    v_mfma_f32_16x16x32_bf16 v[40:43], v[80:83], v[96:99], v[40:43]
    ds_read_b64_tr_b16 v[108:109], v9 offset:6144
    v_xor_b32 v13, 64, v12
    v_mfma_f32_16x16x32_bf16 v[44:47], v[80:83], v[100:103], v[44:47]
    ds_read_b64_tr_b16 v[110:111], v9 offset:6400
    v_lshrrev_b32 v11, 2, v0
    v_mfma_f32_16x16x32_bf16 v[68:71], v[80:83], v[132:135], v[68:71]
    ds_read_b128 v[124:127], v136 offset:32768
    v_and_b32 v11, 4, v11
    v_mfma_f32_16x16x32_bf16 v[48:51], v[84:87], v[88:91], v[48:51]
    ds_read_b128 v[128:131], v136 offset:49152
    s_add_u32 s6, s6, 64
    s_and_b32 s6, s6, 0x3c0
    v_xor_b32 v11, v11, v0
    v_mfma_f32_16x16x32_bf16 v[52:55], v[84:87], v[92:95], v[52:55]
    ds_read_b64_tr_b16 v[112:113], v10 offset:8192
    v_and_b32 v11, 7, v11
    v_mfma_f32_16x16x32_bf16 v[56:59], v[84:87], v[96:99], v[56:59]
    ds_read_b64_tr_b16 v[114:115], v10 offset:8704
    v_lshlrev_b32 v11, 4, v11
    v_mfma_f32_16x16x32_bf16 v[60:63], v[84:87], v[100:103], v[60:63]
    v_lshrrev_b32 v138, 3, v0
    v_mfma_f32_16x16x32_bf16 v[72:75], v[84:87], v[132:135], v[72:75]
    v_lshl_add_u32 v11, v138, 10, v11
    s_waitcnt lgkmcnt(0)
    v_mfma_f32_16x16x32_bf16 v[16:19], v[104:107], v[116:119], v[16:19]
    s_add_u32 m0, s12, 6144
    s_add_u32 s43, s10, s11
    buffer_load_dwordx4 v4, s[48:51], s43 offen lds
    v_mfma_f32_16x16x32_bf16 v[20:23], v[104:107], v[120:123], v[20:23]
    s_add_u32 s68, s13, s11
    buffer_load_dwordx4 v5, s[48:51], s43 offen offset:1024 lds
    v_mfma_f32_16x16x32_bf16 v[24:27], v[104:107], v[124:127], v[24:27]
    s_add_u32 m0, s12, 8192
    s_add_u32 s11, s11, 88064
    buffer_load_dwordx4 v6, s[48:51], s68 offen lds
    s_cmp_eq_u32 s11, 1409024
    s_cselect_b32 s11, 0, s11
    s_waitcnt vmcnt(7)
    v_mfma_f32_16x16x32_bf16 v[28:31], v[104:107], v[128:131], v[28:31]
    v_xor_b32 v136, s6, v7
    ds_read_b64_tr_b16 v[76:77], v8 offset:0
    s_lshl_b32 s35, s7, 7
    v_mfma_f32_16x16x32_bf16 v[64:67], v[104:107], v[132:135], v[64:67]
    ds_read_b64_tr_b16 v[78:79], v8 offset:256
    v_add_u32 v11, s35, v11
    v_mfma_f32_16x16x32_bf16 v[32:35], v[108:111], v[116:119], v[32:35]
    ds_read_b128 v[88:91], v136
    v_and_b32 v138, 15, v0
    v_mfma_f32_16x16x32_bf16 v[36:39], v[108:111], v[120:123], v[36:39]
    ds_read_b128 v[92:95], v136 offset:16384
    v_lshlrev_b32 v138, 3, v138
    v_mfma_f32_16x16x32_bf16 v[40:43], v[108:111], v[124:127], v[40:43]
    ds_read_b64_tr_b16 v[80:81], v9 offset:0
    v_add_u32 v138, 161536, v138
    v_mfma_f32_16x16x32_bf16 v[44:47], v[108:111], v[128:131], v[44:47]
    ds_read_b64_tr_b16 v[82:83], v9 offset:256
    s_mov_b32 s32, 0xbfb8aa3b
    v_mfma_f32_16x16x32_bf16 v[68:71], v[108:111], v[132:135], v[68:71]
    ds_read_b128 v[96:99], v136 offset:32768
    s_mov_b32 s33, 0xbfb8aa3b
    v_mfma_f32_16x16x32_bf16 v[48:51], v[112:115], v[116:119], v[48:51]
    ds_read_b128 v[100:103], v136 offset:49152
    s_add_u32 s6, s6, 64
    s_and_b32 s6, s6, 0x3c0
    s_add_u32 s34, s7, 1
    v_mfma_f32_16x16x32_bf16 v[52:55], v[112:115], v[120:123], v[52:55]
    ds_read_b64_tr_b16 v[84:85], v10 offset:2048
    s_lshl_b32 s36, s3, 3
    v_mfma_f32_16x16x32_bf16 v[56:59], v[112:115], v[124:127], v[56:59]
    ds_read_b64_tr_b16 v[86:87], v10 offset:2560
    s_lshr_b32 s36, 0x05030200, s36
    v_mfma_f32_16x16x32_bf16 v[60:63], v[112:115], v[128:131], v[60:63]
    s_and_b32 s36, s36, 7
    v_mfma_f32_16x16x32_bf16 v[72:75], v[112:115], v[132:135], v[72:75]
    s_mov_b32 s70, s29
    s_waitcnt lgkmcnt(0)
    v_mfma_f32_16x16x32_bf16 v[16:19], v[76:79], v[88:91], v[16:19]
    s_add_u32 m0, s12, 0
    s_add_u32 s43, s10, s11
    buffer_load_dwordx4 v4, s[48:51], s43 offen lds
    v_mfma_f32_16x16x32_bf16 v[20:23], v[76:79], v[92:95], v[20:23]
    s_add_u32 s68, s13, s11
    buffer_load_dwordx4 v5, s[48:51], s43 offen offset:1024 lds
    v_mfma_f32_16x16x32_bf16 v[24:27], v[76:79], v[96:99], v[24:27]
    s_add_u32 m0, s12, 2048
    s_add_u32 s11, s11, 88064
    buffer_load_dwordx4 v6, s[48:51], s68 offen lds
    s_cmp_eq_u32 s11, 1409024
    s_cselect_b32 s11, 0, s11
    s_waitcnt vmcnt(6)
    v_mfma_f32_16x16x32_bf16 v[28:31], v[76:79], v[100:103], v[28:31]
    v_xor_b32 v136, s6, v7
    ds_read_b64_tr_b16 v[104:105], v8 offset:3072
    s_and_b32 s28, s7, 3
    v_mfma_f32_16x16x32_bf16 v[64:67], v[76:79], v[132:135], v[64:67]
    ds_read_b64_tr_b16 v[106:107], v8 offset:3328
    s_add_u32 s35, s28, 0
    s_sub_u32 s37, s35, 7
    s_cmp_ge_u32 s35, 7
    s_cselect_b32 s35, s37, s35
    v_mfma_f32_16x16x32_bf16 v[32:35], v[80:83], v[88:91], v[32:35]
    ds_read_b128 v[116:119], v136
    s_add_u32 s35, s35, s34
    v_mfma_f32_16x16x32_bf16 v[36:39], v[80:83], v[92:95], v[36:39]
    ds_read_b128 v[120:123], v136 offset:16384
    s_and_b32 s35, s35, 7
    v_mfma_f32_16x16x32_bf16 v[40:43], v[80:83], v[96:99], v[40:43]
    ds_read_b64_tr_b16 v[108:109], v9 offset:3072
    s_mul_i32 s35, s35, 43
    v_mfma_f32_16x16x32_bf16 v[44:47], v[80:83], v[100:103], v[44:47]
    ds_read_b64_tr_b16 v[110:111], v9 offset:3328
    s_add_u32 s37, s35, 35
    v_mfma_f32_16x16x32_bf16 v[68:71], v[80:83], v[132:135], v[68:71]
    ds_read_b128 v[124:127], v136 offset:32768
    s_lshr_b32 s35, s35, 3
    v_mfma_f32_16x16x32_bf16 v[48:51], v[84:87], v[88:91], v[48:51]
    ds_read_b128 v[128:131], v136 offset:49152
    s_add_u32 s6, s6, 64
    s_and_b32 s6, s6, 0x3c0
    s_lshr_b32 s37, s37, 3
    v_mfma_f32_16x16x32_bf16 v[52:55], v[84:87], v[92:95], v[52:55]
    ds_read_b64_tr_b16 v[112:113], v10 offset:5120
    s_add_u32 s35, s35, s36
    v_mfma_f32_16x16x32_bf16 v[56:59], v[84:87], v[96:99], v[56:59]
    ds_read_b64_tr_b16 v[114:115], v10 offset:5632
    s_min_u32 s71, s35, s37
    v_mfma_f32_16x16x32_bf16 v[60:63], v[84:87], v[100:103], v[60:63]
    s_add_u32 s35, s28, 1
    s_sub_u32 s37, s35, 7
    s_cmp_ge_u32 s35, 7
    s_cselect_b32 s35, s37, s35
    v_mfma_f32_16x16x32_bf16 v[72:75], v[84:87], v[132:135], v[72:75]
    s_add_u32 s35, s35, s34
    s_waitcnt lgkmcnt(0)
    v_mfma_f32_16x16x32_bf16 v[16:19], v[104:107], v[116:119], v[16:19]
    s_add_u32 m0, s12, 3072
    s_add_u32 s43, s10, s11
    buffer_load_dwordx4 v4, s[48:51], s43 offen lds
    v_mfma_f32_16x16x32_bf16 v[20:23], v[104:107], v[120:123], v[20:23]
    s_add_u32 s68, s13, s11
    buffer_load_dwordx4 v5, s[48:51], s43 offen offset:1024 lds
    v_mfma_f32_16x16x32_bf16 v[24:27], v[104:107], v[124:127], v[24:27]
    s_add_u32 m0, s12, 5120
    s_add_u32 s11, s11, 88064
    buffer_load_dwordx4 v6, s[48:51], s68 offen lds
    s_cmp_eq_u32 s11, 1409024
    s_cselect_b32 s11, 0, s11
    s_waitcnt vmcnt(6)
    v_mfma_f32_16x16x32_bf16 v[28:31], v[104:107], v[128:131], v[28:31]
    v_xor_b32 v136, s6, v7
    ds_read_b64_tr_b16 v[76:77], v8 offset:6144
    s_and_b32 s35, s35, 7
    v_mfma_f32_16x16x32_bf16 v[64:67], v[104:107], v[132:135], v[64:67]
    ds_read_b64_tr_b16 v[78:79], v8 offset:6400
    s_mul_i32 s35, s35, 43
    v_mfma_f32_16x16x32_bf16 v[32:35], v[108:111], v[116:119], v[32:35]
    ds_read_b128 v[88:91], v136
    s_add_u32 s37, s35, 35
    v_mfma_f32_16x16x32_bf16 v[36:39], v[108:111], v[120:123], v[36:39]
    ds_read_b128 v[92:95], v136 offset:16384
    s_lshr_b32 s35, s35, 3
    v_mfma_f32_16x16x32_bf16 v[40:43], v[108:111], v[124:127], v[40:43]
    ds_read_b64_tr_b16 v[80:81], v9 offset:6144
    s_lshr_b32 s37, s37, 3
    v_mfma_f32_16x16x32_bf16 v[44:47], v[108:111], v[128:131], v[44:47]
    ds_read_b64_tr_b16 v[82:83], v9 offset:6400
    s_add_u32 s35, s35, s36
    v_mfma_f32_16x16x32_bf16 v[68:71], v[108:111], v[132:135], v[68:71]
    ds_read_b128 v[96:99], v136 offset:32768
    s_min_u32 s72, s35, s37
    v_mfma_f32_16x16x32_bf16 v[48:51], v[112:115], v[116:119], v[48:51]
    ds_read_b128 v[100:103], v136 offset:49152
    s_add_u32 s6, s6, 64
    s_and_b32 s6, s6, 0x3c0
    s_add_u32 s35, s28, 2
    s_sub_u32 s37, s35, 7
    s_cmp_ge_u32 s35, 7
    s_cselect_b32 s35, s37, s35
    v_mfma_f32_16x16x32_bf16 v[52:55], v[112:115], v[120:123], v[52:55]
    ds_read_b64_tr_b16 v[84:85], v10 offset:8192
    s_add_u32 s35, s35, s34
    v_mfma_f32_16x16x32_bf16 v[56:59], v[112:115], v[124:127], v[56:59]
    ds_read_b64_tr_b16 v[86:87], v10 offset:8704
    s_and_b32 s35, s35, 7
    v_mfma_f32_16x16x32_bf16 v[60:63], v[112:115], v[128:131], v[60:63]
    s_mul_i32 s35, s35, 43
    v_mfma_f32_16x16x32_bf16 v[72:75], v[112:115], v[132:135], v[72:75]
    s_add_u32 s37, s35, 35
    s_waitcnt lgkmcnt(0)
    v_mfma_f32_16x16x32_bf16 v[16:19], v[76:79], v[88:91], v[16:19]
    s_add_u32 m0, s12, 6144
    s_add_u32 s43, s10, s11
    buffer_load_dwordx4 v4, s[48:51], s43 offen lds
    v_mfma_f32_16x16x32_bf16 v[20:23], v[76:79], v[92:95], v[20:23]
    s_add_u32 s68, s13, s11
    buffer_load_dwordx4 v5, s[48:51], s43 offen offset:1024 lds
    v_mfma_f32_16x16x32_bf16 v[24:27], v[76:79], v[96:99], v[24:27]
    s_add_u32 m0, s12, 8192
    s_add_u32 s11, s11, 88064
    buffer_load_dwordx4 v6, s[48:51], s68 offen lds
    s_cmp_eq_u32 s11, 1409024
    s_cselect_b32 s11, 0, s11
    s_waitcnt vmcnt(6)
    v_mfma_f32_16x16x32_bf16 v[28:31], v[76:79], v[100:103], v[28:31]
    v_xor_b32 v136, s6, v7
    ds_read_b64_tr_b16 v[104:105], v8 offset:0
    s_lshr_b32 s35, s35, 3
    s_lshr_b32 s37, s37, 3
    v_mfma_f32_16x16x32_bf16 v[64:67], v[76:79], v[132:135], v[64:67]
    ds_read_b64_tr_b16 v[106:107], v8 offset:256
    s_add_u32 s35, s35, s36
    s_min_u32 s73, s35, s37
    v_mfma_f32_16x16x32_bf16 v[32:35], v[80:83], v[88:91], v[32:35]
    ds_read_b128 v[116:119], v136
    s_add_u32 s35, s28, 3
    s_sub_u32 s37, s35, 7
    s_cmp_ge_u32 s35, 7
    s_cselect_b32 s35, s37, s35
    s_add_u32 s35, s35, s34
    v_mfma_f32_16x16x32_bf16 v[36:39], v[80:83], v[92:95], v[36:39]
    ds_read_b128 v[120:123], v136 offset:16384
    s_and_b32 s35, s35, 7
    s_mul_i32 s35, s35, 43
    v_mfma_f32_16x16x32_bf16 v[40:43], v[80:83], v[96:99], v[40:43]
    ds_read_b64_tr_b16 v[108:109], v9 offset:0
    s_add_u32 s37, s35, 35
    s_lshr_b32 s35, s35, 3
    v_mfma_f32_16x16x32_bf16 v[44:47], v[80:83], v[100:103], v[44:47]
    ds_read_b64_tr_b16 v[110:111], v9 offset:256
    s_lshr_b32 s37, s37, 3
    s_add_u32 s35, s35, s36
    v_mfma_f32_16x16x32_bf16 v[68:71], v[80:83], v[132:135], v[68:71]
    ds_read_b128 v[124:127], v136 offset:32768
    s_min_u32 s74, s35, s37
    s_add_u32 s35, s28, 4
    s_sub_u32 s37, s35, 7
    s_cmp_ge_u32 s35, 7
    s_cselect_b32 s35, s37, s35
    v_mfma_f32_16x16x32_bf16 v[48:51], v[84:87], v[88:91], v[48:51]
    ds_read_b128 v[128:131], v136 offset:49152
    s_add_u32 s6, s6, 64
    s_and_b32 s6, s6, 0x3c0
    s_add_u32 s35, s35, s34
    s_and_b32 s35, s35, 7
    v_mfma_f32_16x16x32_bf16 v[52:55], v[84:87], v[92:95], v[52:55]
    ds_read_b64_tr_b16 v[112:113], v10 offset:2048
    s_mul_i32 s35, s35, 43
    s_add_u32 s37, s35, 35
    v_mfma_f32_16x16x32_bf16 v[56:59], v[84:87], v[96:99], v[56:59]
    ds_read_b64_tr_b16 v[114:115], v10 offset:2560
    s_lshr_b32 s35, s35, 3
    s_lshr_b32 s37, s37, 3
    v_mfma_f32_16x16x32_bf16 v[60:63], v[84:87], v[100:103], v[60:63]
    s_add_u32 s35, s35, s36
    s_min_u32 s75, s35, s37
    v_mfma_f32_16x16x32_bf16 v[72:75], v[84:87], v[132:135], v[72:75]
    s_add_u32 s35, s28, 5
    s_sub_u32 s37, s35, 7
    s_cmp_ge_u32 s35, 7
    s_cselect_b32 s35, s37, s35
    s_add_u32 s35, s35, s34
    s_waitcnt lgkmcnt(0)
    v_mfma_f32_16x16x32_bf16 v[16:19], v[104:107], v[116:119], v[16:19]
    s_add_u32 m0, s12, 0
    s_add_u32 s43, s10, s11
    buffer_load_dwordx4 v4, s[48:51], s43 offen lds
    v_mfma_f32_16x16x32_bf16 v[20:23], v[104:107], v[120:123], v[20:23]
    s_add_u32 s68, s13, s11
    buffer_load_dwordx4 v5, s[48:51], s43 offen offset:1024 lds
    v_mfma_f32_16x16x32_bf16 v[24:27], v[104:107], v[124:127], v[24:27]
    s_add_u32 m0, s12, 2048
    s_add_u32 s11, s11, 88064
    buffer_load_dwordx4 v6, s[48:51], s68 offen lds
    s_cmp_eq_u32 s11, 1409024
    s_cselect_b32 s11, 0, s11
    s_waitcnt vmcnt(6)
    v_mfma_f32_16x16x32_bf16 v[28:31], v[104:107], v[128:131], v[28:31]
    v_xor_b32 v136, s6, v7
    ds_read_b64_tr_b16 v[76:77], v8 offset:3072
    s_and_b32 s35, s35, 7
    s_mul_i32 s35, s35, 43
    v_mfma_f32_16x16x32_bf16 v[64:67], v[104:107], v[132:135], v[64:67]
    ds_read_b64_tr_b16 v[78:79], v8 offset:3328
    s_add_u32 s37, s35, 35
    s_lshr_b32 s35, s35, 3
    v_mfma_f32_16x16x32_bf16 v[32:35], v[108:111], v[116:119], v[32:35]
    ds_read_b128 v[88:91], v136
    s_lshr_b32 s37, s37, 3
    s_add_u32 s35, s35, s36
    v_mfma_f32_16x16x32_bf16 v[36:39], v[108:111], v[120:123], v[36:39]
    ds_read_b128 v[92:95], v136 offset:16384
    s_min_u32 s76, s35, s37
    s_add_u32 s35, s28, 6
    s_sub_u32 s37, s35, 7
    s_cmp_ge_u32 s35, 7
    s_cselect_b32 s35, s37, s35
    v_mfma_f32_16x16x32_bf16 v[40:43], v[108:111], v[124:127], v[40:43]
    ds_read_b64_tr_b16 v[80:81], v9 offset:3072
    s_add_u32 s35, s35, s34
    s_and_b32 s35, s35, 7
    v_mfma_f32_16x16x32_bf16 v[44:47], v[108:111], v[128:131], v[44:47]
    ds_read_b64_tr_b16 v[82:83], v9 offset:3328
    s_mul_i32 s35, s35, 43
    s_add_u32 s37, s35, 35
    v_mfma_f32_16x16x32_bf16 v[68:71], v[108:111], v[132:135], v[68:71]
    ds_read_b128 v[96:99], v136 offset:32768
    s_lshr_b32 s35, s35, 3
    s_lshr_b32 s37, s37, 3
    v_mfma_f32_16x16x32_bf16 v[48:51], v[112:115], v[116:119], v[48:51]
    ds_read_b128 v[100:103], v136 offset:49152
    s_add_u32 s6, s6, 64
    s_and_b32 s6, s6, 0x3c0
    s_add_u32 s35, s35, s36
    s_min_u32 s77, s35, s37
    v_mfma_f32_16x16x32_bf16 v[52:55], v[112:115], v[120:123], v[52:55]
    ds_read_b64_tr_b16 v[84:85], v10 offset:5120
    s_add_u32 s35, s34, s3
    s_add_u32 s35, s35, 0
    v_mfma_f32_16x16x32_bf16 v[56:59], v[112:115], v[124:127], v[56:59]
    ds_read_b64_tr_b16 v[86:87], v10 offset:5632
    s_and_b32 s35, s35, 7
    s_mul_i32 s35, s35, 43
    v_mfma_f32_16x16x32_bf16 v[60:63], v[112:115], v[128:131], v[60:63]
    s_lshr_b32 s35, s35, 3
    s_add_u32 s78, s35, 1
    v_mfma_f32_16x16x32_bf16 v[72:75], v[112:115], v[132:135], v[72:75]
    s_add_u32 s35, s34, s3
    s_add_u32 s35, s35, 4
    s_waitcnt lgkmcnt(0)
    v_mfma_f32_16x16x32_bf16 v[16:19], v[76:79], v[88:91], v[16:19]
    s_add_u32 m0, s12, 3072
    s_add_u32 s43, s10, s11
    buffer_load_dwordx4 v4, s[48:51], s43 offen lds
    v_mfma_f32_16x16x32_bf16 v[20:23], v[76:79], v[92:95], v[20:23]
    s_add_u32 s68, s13, s11
    buffer_load_dwordx4 v5, s[48:51], s43 offen offset:1024 lds
    v_mfma_f32_16x16x32_bf16 v[24:27], v[76:79], v[96:99], v[24:27]
    s_add_u32 m0, s12, 5120
    s_add_u32 s11, s11, 88064
    buffer_load_dwordx4 v6, s[48:51], s68 offen lds
    s_cmp_eq_u32 s11, 1409024
    s_cselect_b32 s11, 0, s11
    s_waitcnt vmcnt(6)
    v_mfma_f32_16x16x32_bf16 v[28:31], v[76:79], v[100:103], v[28:31]
    v_xor_b32 v136, s6, v7
    ds_read_b64_tr_b16 v[104:105], v8 offset:6144
    s_and_b32 s35, s35, 7
    s_mul_i32 s35, s35, 43
    v_mfma_f32_16x16x32_bf16 v[64:67], v[76:79], v[132:135], v[64:67]
    ds_read_b64_tr_b16 v[106:107], v8 offset:6400
    s_lshr_b32 s35, s35, 3
    s_add_u32 s79, s35, 1
    v_mfma_f32_16x16x32_bf16 v[32:35], v[80:83], v[88:91], v[32:35]
    ds_read_b128 v[116:119], v136
    s_lshl_b32 s35, s3, 4
    s_add_u32 s35, s35, 14
    v_mfma_f32_16x16x32_bf16 v[36:39], v[80:83], v[92:95], v[36:39]
    ds_read_b128 v[120:123], v136 offset:16384
    s_min_u32 s35, s35, 41
    s_cmp_eq_u32 s3, 3
    s_cselect_b32 s80, 0x10000, s35
    v_mfma_f32_16x16x32_bf16 v[40:43], v[80:83], v[96:99], v[40:43]
    ds_read_b64_tr_b16 v[108:109], v9 offset:6144
    v_mfma_f32_16x16x32_bf16 v[44:47], v[80:83], v[100:103], v[44:47]
    ds_read_b64_tr_b16 v[110:111], v9 offset:6400
    v_mfma_f32_16x16x32_bf16 v[68:71], v[80:83], v[132:135], v[68:71]
    ds_read_b128 v[124:127], v136 offset:32768
    v_mfma_f32_16x16x32_bf16 v[48:51], v[84:87], v[88:91], v[48:51]
    ds_read_b128 v[128:131], v136 offset:49152
    s_add_u32 s6, s6, 64
    s_and_b32 s6, s6, 0x3c0
    v_mfma_f32_16x16x32_bf16 v[52:55], v[84:87], v[92:95], v[52:55]
    ds_read_b64_tr_b16 v[112:113], v10 offset:8192
    v_mfma_f32_16x16x32_bf16 v[56:59], v[84:87], v[96:99], v[56:59]
    ds_read_b64_tr_b16 v[114:115], v10 offset:8704
    v_mfma_f32_16x16x32_bf16 v[60:63], v[84:87], v[100:103], v[60:63]
    v_mfma_f32_16x16x32_bf16 v[72:75], v[84:87], v[132:135], v[72:75]
    s_waitcnt lgkmcnt(0)
    v_mfma_f32_16x16x32_bf16 v[16:19], v[104:107], v[116:119], v[16:19]
    s_add_u32 m0, s12, 6144
    s_add_u32 s43, s10, s11
    buffer_load_dwordx4 v4, s[48:51], s43 offen lds
    v_mfma_f32_16x16x32_bf16 v[20:23], v[104:107], v[120:123], v[20:23]
    s_add_u32 s68, s13, s11
    buffer_load_dwordx4 v5, s[48:51], s43 offen offset:1024 lds
    v_mfma_f32_16x16x32_bf16 v[24:27], v[104:107], v[124:127], v[24:27]
    s_add_u32 m0, s12, 8192
    s_add_u32 s11, s11, 88064
    buffer_load_dwordx4 v6, s[48:51], s68 offen lds
    s_cmp_eq_u32 s11, 1409024
    s_cselect_b32 s11, 0, s11
    s_waitcnt vmcnt(6)
    v_mfma_f32_16x16x32_bf16 v[28:31], v[104:107], v[128:131], v[28:31]
    v_xor_b32 v136, s6, v7
    ds_read_b64_tr_b16 v[76:77], v8 offset:0
    v_mfma_f32_16x16x32_bf16 v[64:67], v[104:107], v[132:135], v[64:67]
    ds_read_b64_tr_b16 v[78:79], v8 offset:256
    v_mfma_f32_16x16x32_bf16 v[32:35], v[108:111], v[116:119], v[32:35]
    ds_read_b128 v[88:91], v136
    v_mfma_f32_16x16x32_bf16 v[36:39], v[108:111], v[120:123], v[36:39]
    ds_read_b128 v[92:95], v136 offset:16384
    v_mfma_f32_16x16x32_bf16 v[40:43], v[108:111], v[124:127], v[40:43]
    ds_read_b64_tr_b16 v[80:81], v9 offset:0
    v_mfma_f32_16x16x32_bf16 v[44:47], v[108:111], v[128:131], v[44:47]
    ds_read_b64_tr_b16 v[82:83], v9 offset:256
    v_mfma_f32_16x16x32_bf16 v[68:71], v[108:111], v[132:135], v[68:71]
    ds_read_b128 v[96:99], v136 offset:32768
    v_mfma_f32_16x16x32_bf16 v[48:51], v[112:115], v[116:119], v[48:51]
    ds_read_b128 v[100:103], v136 offset:49152
    s_add_u32 s6, s6, 64
    s_and_b32 s6, s6, 0x3c0
    v_mfma_f32_16x16x32_bf16 v[52:55], v[112:115], v[120:123], v[52:55]
    ds_read_b64_tr_b16 v[84:85], v10 offset:2048
    v_mfma_f32_16x16x32_bf16 v[56:59], v[112:115], v[124:127], v[56:59]
    ds_read_b64_tr_b16 v[86:87], v10 offset:2560
    v_mfma_f32_16x16x32_bf16 v[60:63], v[112:115], v[128:131], v[60:63]
    v_mfma_f32_16x16x32_bf16 v[72:75], v[112:115], v[132:135], v[72:75]
    s_waitcnt lgkmcnt(0)
    v_mfma_f32_16x16x32_bf16 v[16:19], v[76:79], v[88:91], v[16:19]
    s_add_u32 m0, s12, 0
    s_add_u32 s43, s10, s11
    buffer_load_dwordx4 v4, s[48:51], s43 offen lds
    v_mfma_f32_16x16x32_bf16 v[20:23], v[76:79], v[92:95], v[20:23]
    s_add_u32 s68, s13, s11
    buffer_load_dwordx4 v5, s[48:51], s43 offen offset:1024 lds
    v_mfma_f32_16x16x32_bf16 v[24:27], v[76:79], v[96:99], v[24:27]
    s_add_u32 m0, s12, 2048
    s_add_u32 s11, s11, 88064
    buffer_load_dwordx4 v6, s[48:51], s68 offen lds
    s_cmp_eq_u32 s11, 1409024
    s_cselect_b32 s11, 0, s11
    s_mov_b64 exec, 1
    ds_add_u32 v2, v14 offset:120
    s_mov_b64 exec, -1
    s_waitcnt vmcnt(6)
    v_mfma_f32_16x16x32_bf16 v[28:31], v[76:79], v[100:103], v[28:31]
    v_xor_b32 v136, s6, v7
    ds_read_b64_tr_b16 v[104:105], v8 offset:3072
    v_mfma_f32_16x16x32_bf16 v[64:67], v[76:79], v[132:135], v[64:67]
    ds_read_b64_tr_b16 v[106:107], v8 offset:3328
    v_mfma_f32_16x16x32_bf16 v[32:35], v[80:83], v[88:91], v[32:35]
    ds_read_b128 v[116:119], v136
    v_mfma_f32_16x16x32_bf16 v[36:39], v[80:83], v[92:95], v[36:39]
    ds_read_b128 v[120:123], v136 offset:16384
    v_mfma_f32_16x16x32_bf16 v[40:43], v[80:83], v[96:99], v[40:43]
    ds_read_b64_tr_b16 v[108:109], v9 offset:3072
    v_mfma_f32_16x16x32_bf16 v[44:47], v[80:83], v[100:103], v[44:47]
    ds_read_b64_tr_b16 v[110:111], v9 offset:3328
    v_mfma_f32_16x16x32_bf16 v[68:71], v[80:83], v[132:135], v[68:71]
    ds_read_b128 v[124:127], v136 offset:32768
    v_mfma_f32_16x16x32_bf16 v[48:51], v[84:87], v[88:91], v[48:51]
    ds_read_b128 v[128:131], v136 offset:49152
    s_add_u32 s6, s6, 64
    s_and_b32 s6, s6, 0x3c0
    v_mfma_f32_16x16x32_bf16 v[52:55], v[84:87], v[92:95], v[52:55]
    ds_read_b64_tr_b16 v[112:113], v10 offset:5120
    v_mfma_f32_16x16x32_bf16 v[56:59], v[84:87], v[96:99], v[56:59]
    ds_read_b64_tr_b16 v[114:115], v10 offset:5632
    v_mfma_f32_16x16x32_bf16 v[60:63], v[84:87], v[100:103], v[60:63]
    v_mfma_f32_16x16x32_bf16 v[72:75], v[84:87], v[132:135], v[72:75]
    s_waitcnt lgkmcnt(0)
    v_mfma_f32_16x16x32_bf16 v[16:19], v[104:107], v[116:119], v[16:19]
    v_mfma_f32_16x16x32_bf16 v[20:23], v[104:107], v[120:123], v[20:23]
    v_mfma_f32_16x16x32_bf16 v[24:27], v[104:107], v[124:127], v[24:27]
    s_waitcnt vmcnt(3)
    v_mfma_f32_16x16x32_bf16 v[28:31], v[104:107], v[128:131], v[28:31]
    v_xor_b32 v136, s6, v7
    ds_read_b64_tr_b16 v[76:77], v8 offset:6144
    v_mfma_f32_16x16x32_bf16 v[64:67], v[104:107], v[132:135], v[64:67]
    ds_read_b64_tr_b16 v[78:79], v8 offset:6400
    v_mfma_f32_16x16x32_bf16 v[32:35], v[108:111], v[116:119], v[32:35]
    ds_read_b128 v[88:91], v136
    v_mfma_f32_16x16x32_bf16 v[36:39], v[108:111], v[120:123], v[36:39]
    ds_read_b128 v[92:95], v136 offset:16384
    v_mfma_f32_16x16x32_bf16 v[40:43], v[108:111], v[124:127], v[40:43]
    ds_read_b64_tr_b16 v[80:81], v9 offset:6144
    v_mfma_f32_16x16x32_bf16 v[44:47], v[108:111], v[128:131], v[44:47]
    ds_read_b64_tr_b16 v[82:83], v9 offset:6400
    v_mfma_f32_16x16x32_bf16 v[68:71], v[108:111], v[132:135], v[68:71]
    ds_read_b128 v[96:99], v136 offset:32768
    v_mfma_f32_16x16x32_bf16 v[48:51], v[112:115], v[116:119], v[48:51]
    ds_read_b128 v[100:103], v136 offset:49152
    s_add_u32 s6, s6, 64
    s_and_b32 s6, s6, 0x3c0
    v_mfma_f32_16x16x32_bf16 v[52:55], v[112:115], v[120:123], v[52:55]
    ds_read_b64_tr_b16 v[84:85], v10 offset:8192
    v_mfma_f32_16x16x32_bf16 v[56:59], v[112:115], v[124:127], v[56:59]
    ds_read_b64_tr_b16 v[86:87], v10 offset:8704
    v_mfma_f32_16x16x32_bf16 v[60:63], v[112:115], v[128:131], v[60:63]
    v_mfma_f32_16x16x32_bf16 v[72:75], v[112:115], v[132:135], v[72:75]
    s_waitcnt lgkmcnt(0)
    v_mfma_f32_16x16x32_bf16 v[16:19], v[76:79], v[88:91], v[16:19]
    v_mfma_f32_16x16x32_bf16 v[20:23], v[76:79], v[92:95], v[20:23]
    v_mfma_f32_16x16x32_bf16 v[24:27], v[76:79], v[96:99], v[24:27]
    s_waitcnt vmcnt(0)
    v_mfma_f32_16x16x32_bf16 v[28:31], v[76:79], v[100:103], v[28:31]
    v_xor_b32 v136, s6, v7
    ds_read_b64_tr_b16 v[104:105], v8 offset:0
    v_mfma_f32_16x16x32_bf16 v[64:67], v[76:79], v[132:135], v[64:67]
    ds_read_b64_tr_b16 v[106:107], v8 offset:256
    v_mfma_f32_16x16x32_bf16 v[32:35], v[80:83], v[88:91], v[32:35]
    ds_read_b128 v[116:119], v136
    v_mfma_f32_16x16x32_bf16 v[36:39], v[80:83], v[92:95], v[36:39]
    ds_read_b128 v[120:123], v136 offset:16384
    v_mfma_f32_16x16x32_bf16 v[40:43], v[80:83], v[96:99], v[40:43]
    ds_read_b64_tr_b16 v[108:109], v9 offset:0
    v_mfma_f32_16x16x32_bf16 v[44:47], v[80:83], v[100:103], v[44:47]
    ds_read_b64_tr_b16 v[110:111], v9 offset:256
    v_mfma_f32_16x16x32_bf16 v[68:71], v[80:83], v[132:135], v[68:71]
    ds_read_b128 v[124:127], v136 offset:32768
    v_mfma_f32_16x16x32_bf16 v[48:51], v[84:87], v[88:91], v[48:51]
    ds_read_b128 v[128:131], v136 offset:49152
    s_add_u32 s6, s6, 64
    s_and_b32 s6, s6, 0x3c0
    v_mfma_f32_16x16x32_bf16 v[52:55], v[84:87], v[92:95], v[52:55]
    ds_read_b64_tr_b16 v[112:113], v10 offset:2048
    v_mfma_f32_16x16x32_bf16 v[56:59], v[84:87], v[96:99], v[56:59]
    ds_read_b64_tr_b16 v[114:115], v10 offset:2560
    v_mfma_f32_16x16x32_bf16 v[60:63], v[84:87], v[100:103], v[60:63]
    v_mfma_f32_16x16x32_bf16 v[72:75], v[84:87], v[132:135], v[72:75]
    s_waitcnt lgkmcnt(0)
    v_mfma_f32_16x16x32_bf16 v[16:19], v[104:107], v[116:119], v[16:19]
    v_mfma_f32_16x16x32_bf16 v[20:23], v[104:107], v[120:123], v[20:23]
    v_mfma_f32_16x16x32_bf16 v[24:27], v[104:107], v[124:127], v[24:27]
    v_mfma_f32_16x16x32_bf16 v[28:31], v[104:107], v[128:131], v[28:31]
    ds_read_b64 v[76:77], v138 offset:512
    ds_read_b32 v96, v138 offset:1024
    v_mfma_f32_16x16x32_bf16 v[64:67], v[104:107], v[132:135], v[64:67]
    ds_read_b64 v[78:79], v138 offset:640
    ds_read_b32 v98, v138 offset:1152
    v_mfma_f32_16x16x32_bf16 v[32:35], v[108:111], v[116:119], v[32:35]
    ds_read_b64 v[80:81], v138 offset:768
    ds_read_b32 v100, v138 offset:1280
    v_mfma_f32_16x16x32_bf16 v[36:39], v[108:111], v[120:123], v[36:39]
    ds_read_b64 v[82:83], v138 offset:896
    ds_read_b32 v102, v138 offset:1408
    v_mfma_f32_16x16x32_bf16 v[40:43], v[108:111], v[124:127], v[40:43]
    s_lshl_b32 s42, s5, 7
    s_add_u32 s42, s42, s15
    v_xor_b32 v136, s42, v7
    v_mfma_f32_16x16x32_bf16 v[44:47], v[108:111], v[128:131], v[44:47]
    v_xor_b32 v137, 64, v136
    ds_read_b128 v[148:151], v136
    v_mfma_f32_16x16x32_bf16 v[68:71], v[108:111], v[132:135], v[68:71]
    ds_read_b128 v[152:155], v137
    v_mfma_f32_16x16x32_bf16 v[48:51], v[112:115], v[116:119], v[48:51]
    s_mov_b64 exec, 1
    ds_add_u32 v2, v14 offset:4
    s_mov_b64 exec, -1
    v_mfma_f32_16x16x32_bf16 v[52:55], v[112:115], v[120:123], v[52:55]
    v_mfma_f32_16x16x32_bf16 v[56:59], v[112:115], v[124:127], v[56:59]
    v_mfma_f32_16x16x32_bf16 v[60:63], v[112:115], v[128:131], v[60:63]
    v_mfma_f32_16x16x32_bf16 v[72:75], v[112:115], v[132:135], v[72:75]
    s_setprio 3
    v_xor_b32 v4, 64, v3
    s_waitcnt lgkmcnt(0)
    v_fma_f32 v108, -v64, v76, v16
    v_fma_f32 v109, -v65, v76, v17
    v_fma_f32 v110, -v66, v76, v18
    v_fma_f32 v111, -v67, v76, v19
    v_fma_f32 v112, -v68, v76, v32
    v_fma_f32 v113, -v69, v76, v33
    v_fma_f32 v114, -v70, v76, v34
    v_fma_f32 v115, -v71, v76, v35
    v_fma_f32 v116, -v72, v76, v48
    v_fma_f32 v117, -v73, v76, v49
    v_fma_f32 v118, -v74, v76, v50
    v_fma_f32 v119, -v75, v76, v51
    v_mul_f32 v84, v108, v96
    v_mul_f32 v85, v109, v96
    v_mul_f32 v86, v110, v96
    v_mul_f32 v87, v111, v96
    v_mul_f32 v88, v112, v96
    v_mul_f32 v89, v113, v96
    v_mul_f32 v90, v114, v96
    v_mul_f32 v91, v115, v96
    v_mul_f32 v92, v116, v96
    v_mul_f32 v93, v117, v96
    v_mul_f32 v94, v118, v96
    v_mul_f32 v95, v119, v96
    v_exp_f32 v84, v84
    v_exp_f32 v85, v85
    v_exp_f32 v86, v86
    v_exp_f32 v87, v87
    v_exp_f32 v88, v88
    v_exp_f32 v89, v89
    v_exp_f32 v90, v90
    v_exp_f32 v91, v91
    v_exp_f32 v92, v92
    v_exp_f32 v93, v93
    v_exp_f32 v94, v94
    v_exp_f32 v95, v95
    v_fma_f32 v84, v84, v77, v77
    v_fma_f32 v85, v85, v77, v77
    v_fma_f32 v86, v86, v77, v77
    v_fma_f32 v87, v87, v77, v77
    v_fma_f32 v88, v88, v77, v77
    v_fma_f32 v89, v89, v77, v77
    v_fma_f32 v90, v90, v77, v77
    v_fma_f32 v91, v91, v77, v77
    v_fma_f32 v92, v92, v77, v77
    v_fma_f32 v93, v93, v77, v77
    v_fma_f32 v94, v94, v77, v77
    v_fma_f32 v95, v95, v77, v77
    v_rcp_f32 v84, v84
    v_rcp_f32 v85, v85
    v_rcp_f32 v86, v86
    v_rcp_f32 v87, v87
    v_rcp_f32 v88, v88
    v_rcp_f32 v89, v89
    v_rcp_f32 v90, v90
    v_rcp_f32 v91, v91
    v_rcp_f32 v92, v92
    v_rcp_f32 v93, v93
    v_rcp_f32 v94, v94
    v_rcp_f32 v95, v95
    v_mul_f32 v108, v108, v84
    v_mul_f32 v109, v109, v85
    v_mul_f32 v110, v110, v86
    v_mul_f32 v111, v111, v87
    v_mul_f32 v112, v112, v88
    v_mul_f32 v113, v113, v89
    v_mul_f32 v114, v114, v90
    v_mul_f32 v115, v115, v91
    v_mul_f32 v116, v116, v92
    v_mul_f32 v117, v117, v93
    v_mul_f32 v118, v118, v94
    v_mul_f32 v119, v119, v95
    v_cvt_pk_bf16_f32 v240, v108, v109
    v_cvt_pk_bf16_f32 v241, v110, v111
    v_cvt_pk_bf16_f32 v242, v112, v113
    v_cvt_pk_bf16_f32 v243, v114, v115
    v_cvt_pk_bf16_f32 v120, v116, v117
    v_cvt_pk_bf16_f32 v121, v118, v119
    buffer_store_dwordx4 v[240:243], v1, s[60:63], s0 offen offset:0 sc1
    v_fma_f32 v108, -v64, v78, v20
    v_fma_f32 v109, -v65, v78, v21
    v_fma_f32 v110, -v66, v78, v22
    v_fma_f32 v111, -v67, v78, v23
    v_fma_f32 v112, -v68, v78, v36
    v_fma_f32 v113, -v69, v78, v37
    v_fma_f32 v114, -v70, v78, v38
    v_fma_f32 v115, -v71, v78, v39
    v_fma_f32 v116, -v72, v78, v52
    v_fma_f32 v117, -v73, v78, v53
    v_fma_f32 v118, -v74, v78, v54
    v_fma_f32 v119, -v75, v78, v55
    v_mul_f32 v84, v108, v98
    v_mul_f32 v85, v109, v98
    v_mul_f32 v86, v110, v98
    v_mul_f32 v87, v111, v98
    v_mul_f32 v88, v112, v98
    v_mul_f32 v89, v113, v98
    v_mul_f32 v90, v114, v98
    v_mul_f32 v91, v115, v98
    v_mul_f32 v92, v116, v98
    v_mul_f32 v93, v117, v98
    v_mul_f32 v94, v118, v98
    v_mul_f32 v95, v119, v98
    v_exp_f32 v84, v84
    v_exp_f32 v85, v85
    v_exp_f32 v86, v86
    v_exp_f32 v87, v87
    v_exp_f32 v88, v88
    v_exp_f32 v89, v89
    v_exp_f32 v90, v90
    v_exp_f32 v91, v91
    v_exp_f32 v92, v92
    v_exp_f32 v93, v93
    v_exp_f32 v94, v94
    v_exp_f32 v95, v95
    v_fma_f32 v84, v84, v79, v79
    v_fma_f32 v85, v85, v79, v79
    v_fma_f32 v86, v86, v79, v79
    v_fma_f32 v87, v87, v79, v79
    v_fma_f32 v88, v88, v79, v79
    v_fma_f32 v89, v89, v79, v79
    v_fma_f32 v90, v90, v79, v79
    v_fma_f32 v91, v91, v79, v79
    v_fma_f32 v92, v92, v79, v79
    v_fma_f32 v93, v93, v79, v79
    v_fma_f32 v94, v94, v79, v79
    v_fma_f32 v95, v95, v79, v79
    v_rcp_f32 v84, v84
    v_rcp_f32 v85, v85
    v_rcp_f32 v86, v86
    v_rcp_f32 v87, v87
    v_rcp_f32 v88, v88
    v_rcp_f32 v89, v89
    v_rcp_f32 v90, v90
    v_rcp_f32 v91, v91
    v_rcp_f32 v92, v92
    v_rcp_f32 v93, v93
    v_rcp_f32 v94, v94
    v_rcp_f32 v95, v95
    v_mul_f32 v108, v108, v84
    v_mul_f32 v109, v109, v85
    v_mul_f32 v110, v110, v86
    v_mul_f32 v111, v111, v87
    v_mul_f32 v112, v112, v88
    v_mul_f32 v113, v113, v89
    v_mul_f32 v114, v114, v90
    v_mul_f32 v115, v115, v91
    v_mul_f32 v116, v116, v92
    v_mul_f32 v117, v117, v93
    v_mul_f32 v118, v118, v94
    v_mul_f32 v119, v119, v95
    v_cvt_pk_bf16_f32 v244, v108, v109
    v_cvt_pk_bf16_f32 v245, v110, v111
    v_cvt_pk_bf16_f32 v246, v112, v113
    v_cvt_pk_bf16_f32 v247, v114, v115
    v_cvt_pk_bf16_f32 v122, v116, v117
    v_cvt_pk_bf16_f32 v123, v118, v119
    buffer_store_dwordx4 v[244:247], v1, s[60:63], s0 offen offset:1024 sc1
    buffer_store_dwordx4 v[120:123], v1, s[60:63], s1 offen offset:0 sc1
    v_fma_f32 v108, -v64, v80, v24
    v_fma_f32 v109, -v65, v80, v25
    v_fma_f32 v110, -v66, v80, v26
    v_fma_f32 v111, -v67, v80, v27
    v_fma_f32 v112, -v68, v80, v40
    v_fma_f32 v113, -v69, v80, v41
    v_fma_f32 v114, -v70, v80, v42
    v_fma_f32 v115, -v71, v80, v43
    v_fma_f32 v116, -v72, v80, v56
    v_fma_f32 v117, -v73, v80, v57
    v_fma_f32 v118, -v74, v80, v58
    v_fma_f32 v119, -v75, v80, v59
    v_mul_f32 v84, v108, v100
    v_mul_f32 v85, v109, v100
    v_mul_f32 v86, v110, v100
    v_mul_f32 v87, v111, v100
    v_mul_f32 v88, v112, v100
    v_mul_f32 v89, v113, v100
    v_mul_f32 v90, v114, v100
    v_mul_f32 v91, v115, v100
    v_mul_f32 v92, v116, v100
    v_mul_f32 v93, v117, v100
    v_mul_f32 v94, v118, v100
    v_mul_f32 v95, v119, v100
    v_exp_f32 v84, v84
    v_exp_f32 v85, v85
    v_exp_f32 v86, v86
    v_exp_f32 v87, v87
    v_exp_f32 v88, v88
    v_exp_f32 v89, v89
    v_exp_f32 v90, v90
    v_exp_f32 v91, v91
    v_exp_f32 v92, v92
    v_exp_f32 v93, v93
    v_exp_f32 v94, v94
    v_exp_f32 v95, v95
    v_fma_f32 v84, v84, v81, v81
    v_fma_f32 v85, v85, v81, v81
    v_fma_f32 v86, v86, v81, v81
    v_fma_f32 v87, v87, v81, v81
    v_fma_f32 v88, v88, v81, v81
    v_fma_f32 v89, v89, v81, v81
    v_fma_f32 v90, v90, v81, v81
    v_fma_f32 v91, v91, v81, v81
    v_fma_f32 v92, v92, v81, v81
    v_fma_f32 v93, v93, v81, v81
    v_fma_f32 v94, v94, v81, v81
    v_fma_f32 v95, v95, v81, v81
    v_rcp_f32 v84, v84
    v_rcp_f32 v85, v85
    v_rcp_f32 v86, v86
    v_rcp_f32 v87, v87
    v_rcp_f32 v88, v88
    v_rcp_f32 v89, v89
    v_rcp_f32 v90, v90
    v_rcp_f32 v91, v91
    v_rcp_f32 v92, v92
    v_rcp_f32 v93, v93
    v_rcp_f32 v94, v94
    v_rcp_f32 v95, v95
    v_mul_f32 v108, v108, v84
    v_mul_f32 v109, v109, v85
    v_mul_f32 v110, v110, v86
    v_mul_f32 v111, v111, v87
    v_mul_f32 v112, v112, v88
    v_mul_f32 v113, v113, v89
    v_mul_f32 v114, v114, v90
    v_mul_f32 v115, v115, v91
    v_mul_f32 v116, v116, v92
    v_mul_f32 v117, v117, v93
    v_mul_f32 v118, v118, v94
    v_mul_f32 v119, v119, v95
    v_cvt_pk_bf16_f32 v248, v108, v109
    v_cvt_pk_bf16_f32 v249, v110, v111
    v_cvt_pk_bf16_f32 v250, v112, v113
    v_cvt_pk_bf16_f32 v251, v114, v115
    v_cvt_pk_bf16_f32 v124, v116, v117
    v_cvt_pk_bf16_f32 v125, v118, v119
    buffer_store_dwordx4 v[248:251], v1, s[60:63], s0 offen offset:2048 sc1
    v_fma_f32 v108, -v64, v82, v28
    v_fma_f32 v109, -v65, v82, v29
    v_fma_f32 v110, -v66, v82, v30
    v_fma_f32 v111, -v67, v82, v31
    v_fma_f32 v112, -v68, v82, v44
    v_fma_f32 v113, -v69, v82, v45
    v_fma_f32 v114, -v70, v82, v46
    v_fma_f32 v115, -v71, v82, v47
    v_fma_f32 v116, -v72, v82, v60
    v_fma_f32 v117, -v73, v82, v61
    v_fma_f32 v118, -v74, v82, v62
    v_fma_f32 v119, -v75, v82, v63
    v_mul_f32 v84, v108, v102
    v_mul_f32 v85, v109, v102
    v_mul_f32 v86, v110, v102
    v_mul_f32 v87, v111, v102
    v_mul_f32 v88, v112, v102
    v_mul_f32 v89, v113, v102
    v_mul_f32 v90, v114, v102
    v_mul_f32 v91, v115, v102
    v_mul_f32 v92, v116, v102
    v_mul_f32 v93, v117, v102
    v_mul_f32 v94, v118, v102
    v_mul_f32 v95, v119, v102
    v_exp_f32 v84, v84
    v_exp_f32 v85, v85
    v_exp_f32 v86, v86
    v_exp_f32 v87, v87
    v_exp_f32 v88, v88
    v_exp_f32 v89, v89
    v_exp_f32 v90, v90
    v_exp_f32 v91, v91
    v_exp_f32 v92, v92
    v_exp_f32 v93, v93
    v_exp_f32 v94, v94
    v_exp_f32 v95, v95
    v_fma_f32 v84, v84, v83, v83
    v_fma_f32 v85, v85, v83, v83
    v_fma_f32 v86, v86, v83, v83
    v_fma_f32 v87, v87, v83, v83
    v_fma_f32 v88, v88, v83, v83
    v_fma_f32 v89, v89, v83, v83
    v_fma_f32 v90, v90, v83, v83
    v_fma_f32 v91, v91, v83, v83
    v_fma_f32 v92, v92, v83, v83
    v_fma_f32 v93, v93, v83, v83
    v_fma_f32 v94, v94, v83, v83
    v_fma_f32 v95, v95, v83, v83
    v_rcp_f32 v84, v84
    v_rcp_f32 v85, v85
    v_rcp_f32 v86, v86
    v_rcp_f32 v87, v87
    v_rcp_f32 v88, v88
    v_rcp_f32 v89, v89
    v_rcp_f32 v90, v90
    v_rcp_f32 v91, v91
    v_rcp_f32 v92, v92
    v_rcp_f32 v93, v93
    v_rcp_f32 v94, v94
    v_rcp_f32 v95, v95
    v_mul_f32 v108, v108, v84
    v_mul_f32 v109, v109, v85
    v_mul_f32 v110, v110, v86
    v_mul_f32 v111, v111, v87
    v_mul_f32 v112, v112, v88
    v_mul_f32 v113, v113, v89
    v_mul_f32 v114, v114, v90
    v_mul_f32 v115, v115, v91
    v_mul_f32 v116, v116, v92
    v_mul_f32 v117, v117, v93
    v_mul_f32 v118, v118, v94
    v_mul_f32 v119, v119, v95
    v_cvt_pk_bf16_f32 v252, v108, v109
    v_cvt_pk_bf16_f32 v253, v110, v111
    v_cvt_pk_bf16_f32 v254, v112, v113
    v_cvt_pk_bf16_f32 v255, v114, v115
    v_cvt_pk_bf16_f32 v126, v116, v117
    v_cvt_pk_bf16_f32 v127, v118, v119
    buffer_store_dwordx4 v[252:255], v1, s[60:63], s0 offen offset:3072 sc1
    buffer_store_dwordx4 v[124:127], v1, s[60:63], s1 offen offset:1024 sc1
    v_mov_b32 v14, 1
    s_mov_b64 exec, 1
    ds_add_u32 v140, v14 offset:64
    s_mov_b64 exec, -1
    s_mov_b32 s83, 0
LW_6:
    ds_read_b32 v14, v2 offset:4
    s_add_u32 s83, s83, 1
    s_waitcnt lgkmcnt(0)
    v_readfirstlane_b32 s42, v14
    s_cmp_gt_u32 s83, 2097152
    s_cbranch_scc1 LWD_7
    s_cmp_ge_u32 s42, 4
    s_cbranch_scc1 LWD_7
    s_sleep 1
    s_branch LW_6
LWD_7:
    s_add_u32 m0, s12, 0
    s_lshl_b32 s43, s70, 15
    buffer_load_dwordx4 v11, s[52:55], s43 offen lds
    s_add_u32 s68, s43, 7168
    buffer_load_dwordx4 v11, s[52:55], s68 offen offset:1024 lds
    s_add_u32 s68, s43, 14336
    buffer_load_dwordx4 v11, s[52:55], s68 offen offset:2048 lds
    s_add_u32 s68, s43, 21504
    buffer_load_dwordx4 v11, s[52:55], s68 offen offset:3072 lds
    s_add_u32 m0, s12, 4096
    s_lshl_b32 s43, s71, 15
    buffer_load_dwordx4 v11, s[52:55], s43 offen lds
    s_add_u32 s68, s43, 7168
    buffer_load_dwordx4 v11, s[52:55], s68 offen offset:1024 lds
    s_add_u32 s68, s43, 14336
    buffer_load_dwordx4 v11, s[52:55], s68 offen offset:2048 lds
    s_add_u32 s68, s43, 21504
    buffer_load_dwordx4 v11, s[52:55], s68 offen offset:3072 lds
    s_mov_b32 s6, s4
    s_xor_b32 s42, s3, 0
    s_lshl_b32 s42, s42, 10
    v_add_u32 v5, s42, v1
    s_xor_b32 s42, s3, 1
    s_lshl_b32 s42, s42, 10
    v_add_u32 v6, s42, v1
    s_xor_b32 s42, s3, 2
    s_lshl_b32 s42, s42, 10
    v_add_u32 v7, s42, v1
    s_xor_b32 s42, s3, 3
    s_lshl_b32 s42, s42, 10
    v_add_u32 v8, s42, v1
    s_lshl_b32 s10, s6, 9
    s_add_u32 s10, s10, 36864
    s_mul_i32 s11, s6, 176128
    s_add_u32 s11, s11, 4325376
    v_and_b32 v14, 15, v0
    v_lshrrev_b32 v15, 4, v0
    v_lshlrev_b32 v15, 4, v15
    v_lshl_add_u32 v9, v14, 10, v15
    s_lshl_b32 s9, s6, 16
    s_add_u32 s9, s9, s15
    s_lshl_b32 s43, s7, 7
    s_add_u32 s9, s9, s43
    v_lshrrev_b32 v14, 3, v0
    v_bfe_u32 v15, v0, 2, 1
    v_lshlrev_b32 v15, 9, v15
    v_lshl_add_u32 v10, v14, 12, v15
    v_and_b32 v14, 3, v0
    v_lshl_add_u32 v10, v14, 4, v10
    s_lshr_b32 s43, s6, 3
    s_lshl_b32 s43, s43, 10
    s_bfe_u32 s68, s6, 0x10002
    s_lshl_b32 s68, s68, 8
    s_add_u32 s43, s43, s68
    s_and_b32 s42, s6, 3
    s_lshl_b32 s42, s42, 6
    s_add_u32 s43, s43, s42
    s_lshl_b32 s42, s7, 18
    s_add_u32 s43, s43, s42
    s_lshl_b32 s42, s3, 16
    s_add_u32 s43, s43, s42
    s_add_u32 s13, s43, 2228224
    s_lshl_b32 s42, s7, 1
    s_lshr_b32 s43, s6, 4
    s_add_u32 s42, s42, s43
    s_lshl_b32 s42, s42, 10
    s_lshl_b32 s43, s3, 8
    s_add_u32 s42, s42, s43
    s_add_u32 s0, s42, 20480
    v_mov_b32 v15, 0
    s_waitcnt vmcnt(8)
    v_mov_b32 v14, s8
    s_mov_b64 exec, 1
    buffer_store_dword v14, v15, s[60:63], s14 offen sc1
    s_mov_b64 exec, -1
    s_setprio 1
    s_add_u32 m0, s15, 0
    s_lshl_b32 s43, s72, 15
    buffer_load_dwordx4 v11, s[52:55], s43 offen lds
    s_add_u32 s68, s43, 7168
    buffer_load_dwordx4 v11, s[52:55], s68 offen offset:1024 lds
    s_add_u32 s68, s43, 14336
    buffer_load_dwordx4 v11, s[52:55], s68 offen offset:2048 lds
    s_add_u32 s68, s43, 21504
    buffer_load_dwordx4 v11, s[52:55], s68 offen offset:3072 lds
    s_add_u32 m0, s15, 4096
    s_lshl_b32 s43, s73, 15
    buffer_load_dwordx4 v11, s[52:55], s43 offen lds
    s_add_u32 s68, s43, 7168
    buffer_load_dwordx4 v11, s[52:55], s68 offen offset:1024 lds
    s_add_u32 s68, s43, 14336
    buffer_load_dwordx4 v11, s[52:55], s68 offen offset:2048 lds
    s_add_u32 s68, s43, 21504
    buffer_load_dwordx4 v11, s[52:55], s68 offen offset:3072 lds
    s_add_u32 m0, s15, 8192
    s_lshl_b32 s43, s74, 15
    buffer_load_dwordx4 v11, s[52:55], s43 offen lds
    s_add_u32 s68, s43, 7168
    buffer_load_dwordx4 v11, s[52:55], s68 offen offset:1024 lds
    s_add_u32 s68, s43, 14336
    buffer_load_dwordx4 v11, s[52:55], s68 offen offset:2048 lds
    s_add_u32 s68, s43, 21504
    buffer_load_dwordx4 v11, s[52:55], s68 offen offset:3072 lds
    s_add_u32 m0, s15, 12288
    s_lshl_b32 s43, s75, 15
    buffer_load_dwordx4 v11, s[52:55], s43 offen lds
    s_add_u32 s68, s43, 7168
    buffer_load_dwordx4 v11, s[52:55], s68 offen offset:1024 lds
    s_add_u32 s68, s43, 14336
    buffer_load_dwordx4 v11, s[52:55], s68 offen offset:2048 lds
    s_add_u32 s68, s43, 21504
    buffer_load_dwordx4 v11, s[52:55], s68 offen offset:3072 lds
    v_and_b32 v14, 0x1ff, v1
    s_waitcnt vmcnt(21)
    ds_read_b64_tr_b16 v[160:161], v3 offset:0
    ds_read_b64_tr_b16 v[162:163], v3 offset:2048
    ds_read_b64_tr_b16 v[164:165], v3 offset:8
    ds_read_b64_tr_b16 v[166:167], v3 offset:2056
    ds_read_b64_tr_b16 v[168:169], v4 offset:0
    ds_read_b64_tr_b16 v[170:171], v4 offset:2048
    ds_read_b64_tr_b16 v[172:173], v4 offset:8
    ds_read_b64_tr_b16 v[174:175], v4 offset:2056
    s_waitcnt vmcnt(17)
    ds_read_b64_tr_b16 v[176:177], v3 offset:4096
    ds_read_b64_tr_b16 v[178:179], v3 offset:6144
    ds_read_b64_tr_b16 v[180:181], v3 offset:4104
    ds_read_b64_tr_b16 v[182:183], v3 offset:6152
    ds_read_b64_tr_b16 v[184:185], v4 offset:4096
    ds_read_b64_tr_b16 v[186:187], v4 offset:6144
    ds_read_b64_tr_b16 v[188:189], v4 offset:4104
    ds_read_b64_tr_b16 v[190:191], v4 offset:6152
    s_waitcnt lgkmcnt(8)
    s_add_u32 m0, s12, 0
    s_lshl_b32 s43, s76, 15
    buffer_load_dwordx4 v11, s[52:55], s43 offen lds
    s_add_u32 s68, s43, 7168
    buffer_load_dwordx4 v11, s[52:55], s68 offen offset:1024 lds
    s_add_u32 s68, s43, 14336
    buffer_load_dwordx4 v11, s[52:55], s68 offen offset:2048 lds
    s_add_u32 s68, s43, 21504
    buffer_load_dwordx4 v11, s[52:55], s68 offen offset:3072 lds
    s_waitcnt vmcnt(16)
    ds_read_b64_tr_b16 v[192:193], v12 offset:0
    ds_read_b64_tr_b16 v[194:195], v12 offset:2048
    ds_read_b64_tr_b16 v[196:197], v12 offset:8
    ds_read_b64_tr_b16 v[198:199], v12 offset:2056
    ds_read_b64_tr_b16 v[200:201], v13 offset:0
    ds_read_b64_tr_b16 v[202:203], v13 offset:2048
    ds_read_b64_tr_b16 v[204:205], v13 offset:8
    ds_read_b64_tr_b16 v[206:207], v13 offset:2056
    s_waitcnt lgkmcnt(8)
    s_add_u32 m0, s12, 4096
    s_lshl_b32 s43, s77, 15
    buffer_load_dwordx4 v11, s[52:55], s43 offen lds
    s_add_u32 s68, s43, 7168
    buffer_load_dwordx4 v11, s[52:55], s68 offen offset:1024 lds
    s_add_u32 s68, s43, 14336
    buffer_load_dwordx4 v11, s[52:55], s68 offen offset:2048 lds
    s_add_u32 s68, s43, 21504
    buffer_load_dwordx4 v11, s[52:55], s68 offen offset:3072 lds
    s_waitcnt vmcnt(16)
    ds_read_b64_tr_b16 v[208:209], v12 offset:4096
    ds_read_b64_tr_b16 v[210:211], v12 offset:6144
    ds_read_b64_tr_b16 v[212:213], v12 offset:4104
    ds_read_b64_tr_b16 v[214:215], v12 offset:6152
    ds_read_b64_tr_b16 v[216:217], v13 offset:4096
    ds_read_b64_tr_b16 v[218:219], v13 offset:6144
    ds_read_b64_tr_b16 v[220:221], v13 offset:4104
    ds_read_b64_tr_b16 v[222:223], v13 offset:6152
    s_waitcnt lgkmcnt(8)
    s_add_u32 m0, s15, 0
    s_lshl_b32 s43, s78, 15
    buffer_load_dwordx4 v11, s[52:55], s43 offen lds
    s_add_u32 s68, s43, 7168
    buffer_load_dwordx4 v11, s[52:55], s68 offen offset:1024 lds
    s_add_u32 s68, s43, 14336
    buffer_load_dwordx4 v11, s[52:55], s68 offen offset:2048 lds
    s_add_u32 s68, s43, 21504
    buffer_load_dwordx4 v11, s[52:55], s68 offen offset:3072 lds
    buffer_load_dword v15, v14, s[60:63], s10 offen sc1
    s_waitcnt vmcnt(17)
    ds_read_b64_tr_b16 v[224:225], v12 offset:8192
    ds_read_b64_tr_b16 v[226:227], v12 offset:10240
    ds_read_b64_tr_b16 v[228:229], v12 offset:8200
    ds_read_b64_tr_b16 v[230:231], v12 offset:10248
    ds_read_b64_tr_b16 v[232:233], v13 offset:8192
    ds_read_b64_tr_b16 v[234:235], v13 offset:10240
    ds_read_b64_tr_b16 v[236:237], v13 offset:8200
    ds_read_b64_tr_b16 v[238:239], v13 offset:10248
    s_waitcnt lgkmcnt(8)
    s_add_u32 m0, s15, 4096
    s_lshl_b32 s43, s79, 15
    buffer_load_dwordx4 v11, s[52:55], s43 offen lds
    s_add_u32 s68, s43, 7168
    buffer_load_dwordx4 v11, s[52:55], s68 offen offset:1024 lds
    s_add_u32 s68, s43, 14336
    buffer_load_dwordx4 v11, s[52:55], s68 offen offset:2048 lds
    s_add_u32 s68, s43, 21504
    buffer_load_dwordx4 v11, s[52:55], s68 offen offset:3072 lds
    s_waitcnt lgkmcnt(0)
    s_add_u32 m0, s15, 8192
    s_lshl_b32 s43, s80, 15
    buffer_load_dwordx4 v11, s[52:55], s43 offen lds
    s_add_u32 s68, s43, 7168
    buffer_load_dwordx4 v11, s[52:55], s68 offen offset:1024 lds
    s_add_u32 s68, s43, 14336
    buffer_load_dwordx4 v11, s[52:55], s68 offen offset:2048 lds
    s_add_u32 s68, s43, 21504
    buffer_load_dwordx4 v11, s[52:55], s68 offen offset:3072 lds
    s_waitcnt vmcnt(8)
    v_cmp_ne_u32 vcc, s8, v15
    s_nop 1
    s_cmp_eq_u64 vcc, 0
    s_cbranch_scc1 HOK_8
    s_mov_b32 s83, 0
PF_9:
    buffer_load_dword v15, v14, s[60:63], s10 offen sc1
    s_add_u32 s83, s83, 1
    s_waitcnt vmcnt(0)
    v_cmp_ne_u32 vcc, s8, v15
    s_cmp_gt_u32 s83, 262144
    s_cbranch_scc1 PFD_10
    s_cmp_eq_u64 vcc, 0
    s_cbranch_scc1 PFD_10
    s_sleep 1
    s_branch PF_9
PFD_10:
HOK_8:
    s_lshl_b32 s43, s71, 12
    s_add_u32 s43, s43, s11
    buffer_load_dwordx4 v[96:99], v5, s[60:63], s43 offen sc1
    buffer_load_dwordx4 v[100:103], v6, s[60:63], s43 offen sc1
    buffer_load_dwordx4 v[104:107], v7, s[60:63], s43 offen sc1
    buffer_load_dwordx4 v[108:111], v8, s[60:63], s43 offen sc1
    s_lshl_b32 s43, s72, 12
    s_add_u32 s43, s43, s11
    buffer_load_dwordx4 v[112:115], v5, s[60:63], s43 offen sc1
    buffer_load_dwordx4 v[116:119], v6, s[60:63], s43 offen sc1
    buffer_load_dwordx4 v[120:123], v7, s[60:63], s43 offen sc1
    buffer_load_dwordx4 v[124:127], v8, s[60:63], s43 offen sc1
    s_lshl_b32 s43, s73, 12
    s_add_u32 s43, s43, s11
    buffer_load_dwordx4 v[128:131], v5, s[60:63], s43 offen sc1
    buffer_load_dwordx4 v[132:135], v6, s[60:63], s43 offen sc1
    buffer_load_dwordx4 v[136:139], v7, s[60:63], s43 offen sc1
    buffer_load_dwordx4 v[140:143], v8, s[60:63], s43 offen sc1
    v_and_b32 v14, 0xff, v1
    s_setprio 1
    s_cmp_eq_u32 s3, 1
    s_cbranch_scc1 OW_12
    s_cmp_eq_u32 s3, 2
    s_cbranch_scc1 OW_13
    s_cmp_eq_u32 s3, 3
    s_cbranch_scc1 OW_14
OW_11:
    v_mfma_f32_16x16x32_bf16 v[16:19], v[160:163], v[240:243], 0
    v_mfma_f32_16x16x32_bf16 v[32:35], v[164:167], v[240:243], 0
    v_mfma_f32_16x16x32_bf16 v[48:51], v[168:171], v[240:243], 0
    v_mfma_f32_16x16x32_bf16 v[64:67], v[172:175], v[240:243], 0
    v_mfma_f32_16x16x32_bf16 v[20:23], v[160:163], v[244:247], 0
    v_mfma_f32_16x16x32_bf16 v[36:39], v[164:167], v[244:247], 0
    v_mfma_f32_16x16x32_bf16 v[52:55], v[168:171], v[244:247], 0
    v_mfma_f32_16x16x32_bf16 v[68:71], v[172:175], v[244:247], 0
    v_mfma_f32_16x16x32_bf16 v[24:27], v[160:163], v[248:251], 0
    v_mfma_f32_16x16x32_bf16 v[40:43], v[164:167], v[248:251], 0
    v_mfma_f32_16x16x32_bf16 v[56:59], v[168:171], v[248:251], 0
    v_mfma_f32_16x16x32_bf16 v[72:75], v[172:175], v[248:251], 0
    v_mfma_f32_16x16x32_bf16 v[28:31], v[160:163], v[252:255], 0
    v_mfma_f32_16x16x32_bf16 v[44:47], v[164:167], v[252:255], 0
    v_mfma_f32_16x16x32_bf16 v[60:63], v[168:171], v[252:255], 0
    v_mfma_f32_16x16x32_bf16 v[76:79], v[172:175], v[252:255], 0
    s_branch OW_15
OW_12:
    v_mfma_f32_16x16x32_bf16 v[20:23], v[160:163], v[240:243], 0
    v_mfma_f32_16x16x32_bf16 v[36:39], v[164:167], v[240:243], 0
    v_mfma_f32_16x16x32_bf16 v[52:55], v[168:171], v[240:243], 0
    v_mfma_f32_16x16x32_bf16 v[68:71], v[172:175], v[240:243], 0
    v_mfma_f32_16x16x32_bf16 v[16:19], v[160:163], v[244:247], 0
    v_mfma_f32_16x16x32_bf16 v[32:35], v[164:167], v[244:247], 0
    v_mfma_f32_16x16x32_bf16 v[48:51], v[168:171], v[244:247], 0
    v_mfma_f32_16x16x32_bf16 v[64:67], v[172:175], v[244:247], 0
    v_mfma_f32_16x16x32_bf16 v[28:31], v[160:163], v[248:251], 0
    v_mfma_f32_16x16x32_bf16 v[44:47], v[164:167], v[248:251], 0
    v_mfma_f32_16x16x32_bf16 v[60:63], v[168:171], v[248:251], 0
    v_mfma_f32_16x16x32_bf16 v[76:79], v[172:175], v[248:251], 0
    v_mfma_f32_16x16x32_bf16 v[24:27], v[160:163], v[252:255], 0
    v_mfma_f32_16x16x32_bf16 v[40:43], v[164:167], v[252:255], 0
    v_mfma_f32_16x16x32_bf16 v[56:59], v[168:171], v[252:255], 0
    v_mfma_f32_16x16x32_bf16 v[72:75], v[172:175], v[252:255], 0
    s_branch OW_15
OW_13:
    v_mfma_f32_16x16x32_bf16 v[24:27], v[160:163], v[240:243], 0
    v_mfma_f32_16x16x32_bf16 v[40:43], v[164:167], v[240:243], 0
    v_mfma_f32_16x16x32_bf16 v[56:59], v[168:171], v[240:243], 0
    v_mfma_f32_16x16x32_bf16 v[72:75], v[172:175], v[240:243], 0
    v_mfma_f32_16x16x32_bf16 v[28:31], v[160:163], v[244:247], 0
    v_mfma_f32_16x16x32_bf16 v[44:47], v[164:167], v[244:247], 0
    v_mfma_f32_16x16x32_bf16 v[60:63], v[168:171], v[244:247], 0
    v_mfma_f32_16x16x32_bf16 v[76:79], v[172:175], v[244:247], 0
    v_mfma_f32_16x16x32_bf16 v[16:19], v[160:163], v[248:251], 0
    v_mfma_f32_16x16x32_bf16 v[32:35], v[164:167], v[248:251], 0
    v_mfma_f32_16x16x32_bf16 v[48:51], v[168:171], v[248:251], 0
    v_mfma_f32_16x16x32_bf16 v[64:67], v[172:175], v[248:251], 0
    v_mfma_f32_16x16x32_bf16 v[20:23], v[160:163], v[252:255], 0
    v_mfma_f32_16x16x32_bf16 v[36:39], v[164:167], v[252:255], 0
    v_mfma_f32_16x16x32_bf16 v[52:55], v[168:171], v[252:255], 0
    v_mfma_f32_16x16x32_bf16 v[68:71], v[172:175], v[252:255], 0
    s_branch OW_15
OW_14:
    v_mfma_f32_16x16x32_bf16 v[28:31], v[160:163], v[240:243], 0
    v_mfma_f32_16x16x32_bf16 v[44:47], v[164:167], v[240:243], 0
    v_mfma_f32_16x16x32_bf16 v[60:63], v[168:171], v[240:243], 0
    v_mfma_f32_16x16x32_bf16 v[76:79], v[172:175], v[240:243], 0
    v_mfma_f32_16x16x32_bf16 v[24:27], v[160:163], v[244:247], 0
    v_mfma_f32_16x16x32_bf16 v[40:43], v[164:167], v[244:247], 0
    v_mfma_f32_16x16x32_bf16 v[56:59], v[168:171], v[244:247], 0
    v_mfma_f32_16x16x32_bf16 v[72:75], v[172:175], v[244:247], 0
    v_mfma_f32_16x16x32_bf16 v[20:23], v[160:163], v[248:251], 0
    v_mfma_f32_16x16x32_bf16 v[36:39], v[164:167], v[248:251], 0
    v_mfma_f32_16x16x32_bf16 v[52:55], v[168:171], v[248:251], 0
    v_mfma_f32_16x16x32_bf16 v[68:71], v[172:175], v[248:251], 0
    v_mfma_f32_16x16x32_bf16 v[16:19], v[160:163], v[252:255], 0
    v_mfma_f32_16x16x32_bf16 v[32:35], v[164:167], v[252:255], 0
    v_mfma_f32_16x16x32_bf16 v[48:51], v[168:171], v[252:255], 0
    v_mfma_f32_16x16x32_bf16 v[64:67], v[172:175], v[252:255], 0
OW_15:
    ds_read_b64_tr_b16 v[240:241], v12 offset:12288
    ds_read_b64_tr_b16 v[242:243], v12 offset:14336
    ds_read_b64_tr_b16 v[244:245], v12 offset:12296
    ds_read_b64_tr_b16 v[246:247], v12 offset:14344
    ds_read_b64_tr_b16 v[248:249], v13 offset:12288
    ds_read_b64_tr_b16 v[250:251], v13 offset:14336
    ds_read_b64_tr_b16 v[252:253], v13 offset:12296
    ds_read_b64_tr_b16 v[254:255], v13 offset:14344
    v_add_u32 v156, s15, v1
    v_lshrrev_b32 v157, 3, v0
    v_lshlrev_b32 v157, 7, v157
    v_and_b32 v158, 3, v0
    v_lshl_add_u32 v157, v158, 5, v157
    v_bfe_u32 v158, v0, 2, 1
    v_lshl_add_u32 v157, v158, 4, v157
    v_add_u32 v157, s12, v157
    v_lshrrev_b32 v158, 5, v0
    v_mul_u32_u24 v158, 9216, v158
    v_bfe_u32 v159, v0, 4, 1
    v_lshl_add_u32 v158, v159, 10, v158
    v_bfe_u32 v159, v0, 2, 2
    v_lshl_add_u32 v158, v159, 7, v158
    v_and_b32 v159, 3, v0
    v_lshl_add_u32 v158, v159, 3, v158
    s_lshl_b32 s42, s3, 5
    s_add_u32 s42, s42, 65536
    v_add_u32 v158, s42, v158
    v_mov_b32 v159, 1
    s_waitcnt vmcnt(8)
    s_waitcnt lgkmcnt(0)
    v_mfma_f32_16x16x32_bf16 v[20:23], v[176:179], v[100:103], v[20:23]
    s_lshl_b32 s43, s74, 12
    s_add_u32 s43, s43, s11
    buffer_load_dwordx4 v[80:83], v5, s[60:63], s43 offen sc1
    v_mfma_f32_16x16x32_bf16 v[36:39], v[180:183], v[100:103], v[36:39]
    buffer_load_dwordx4 v[84:87], v6, s[60:63], s43 offen sc1
    v_mfma_f32_16x16x32_bf16 v[52:55], v[184:187], v[100:103], v[52:55]
    buffer_load_dwordx4 v[88:91], v7, s[60:63], s43 offen sc1
    v_mfma_f32_16x16x32_bf16 v[68:71], v[188:191], v[100:103], v[68:71]
    buffer_load_dwordx4 v[92:95], v8, s[60:63], s43 offen sc1
    v_mfma_f32_16x16x32_bf16 v[24:27], v[176:179], v[104:107], v[24:27]
    ds_read_b64_tr_b16 v[160:161], v3 offset:0
    v_mfma_f32_16x16x32_bf16 v[40:43], v[180:183], v[104:107], v[40:43]
    ds_read_b64_tr_b16 v[162:163], v3 offset:2048
    v_mfma_f32_16x16x32_bf16 v[56:59], v[184:187], v[104:107], v[56:59]
    ds_read_b64_tr_b16 v[164:165], v3 offset:8
    v_mfma_f32_16x16x32_bf16 v[72:75], v[188:191], v[104:107], v[72:75]
    ds_read_b64_tr_b16 v[166:167], v3 offset:2056
    v_mfma_f32_16x16x32_bf16 v[28:31], v[176:179], v[108:111], v[28:31]
    ds_read_b64_tr_b16 v[168:169], v4 offset:0
    v_mfma_f32_16x16x32_bf16 v[44:47], v[180:183], v[108:111], v[44:47]
    ds_read_b64_tr_b16 v[170:171], v4 offset:2048
    v_mfma_f32_16x16x32_bf16 v[60:63], v[184:187], v[108:111], v[60:63]
    ds_read_b64_tr_b16 v[172:173], v4 offset:8
    v_mfma_f32_16x16x32_bf16 v[76:79], v[188:191], v[108:111], v[76:79]
    ds_read_b64_tr_b16 v[174:175], v4 offset:2056
    v_mfma_f32_16x16x32_bf16 v[16:19], v[176:179], v[96:99], v[16:19]
    v_mfma_f32_16x16x32_bf16 v[32:35], v[180:183], v[96:99], v[32:35]
    v_mfma_f32_16x16x32_bf16 v[48:51], v[184:187], v[96:99], v[48:51]
    v_mfma_f32_16x16x32_bf16 v[64:67], v[188:191], v[96:99], v[64:67]
    s_waitcnt vmcnt(8)
    v_mfma_f32_16x16x32_bf16 v[20:23], v[192:195], v[116:119], v[20:23]
    s_lshl_b32 s43, s75, 12
    s_add_u32 s43, s43, s11
    buffer_load_dwordx4 v[96:99], v5, s[60:63], s43 offen sc1
    v_mfma_f32_16x16x32_bf16 v[36:39], v[196:199], v[116:119], v[36:39]
    buffer_load_dwordx4 v[100:103], v6, s[60:63], s43 offen sc1
    v_mfma_f32_16x16x32_bf16 v[52:55], v[200:203], v[116:119], v[52:55]
    buffer_load_dwordx4 v[104:107], v7, s[60:63], s43 offen sc1
    v_mfma_f32_16x16x32_bf16 v[68:71], v[204:207], v[116:119], v[68:71]
    buffer_load_dwordx4 v[108:111], v8, s[60:63], s43 offen sc1
    v_mfma_f32_16x16x32_bf16 v[24:27], v[192:195], v[120:123], v[24:27]
    ds_read_b64_tr_b16 v[176:177], v3 offset:4096
    v_mfma_f32_16x16x32_bf16 v[40:43], v[196:199], v[120:123], v[40:43]
    ds_read_b64_tr_b16 v[178:179], v3 offset:6144
    v_mfma_f32_16x16x32_bf16 v[56:59], v[200:203], v[120:123], v[56:59]
    ds_read_b64_tr_b16 v[180:181], v3 offset:4104
    v_mfma_f32_16x16x32_bf16 v[72:75], v[204:207], v[120:123], v[72:75]
    ds_read_b64_tr_b16 v[182:183], v3 offset:6152
    v_mfma_f32_16x16x32_bf16 v[28:31], v[192:195], v[124:127], v[28:31]
    ds_read_b64_tr_b16 v[184:185], v4 offset:4096
    v_mfma_f32_16x16x32_bf16 v[44:47], v[196:199], v[124:127], v[44:47]
    ds_read_b64_tr_b16 v[186:187], v4 offset:6144
    v_mfma_f32_16x16x32_bf16 v[60:63], v[200:203], v[124:127], v[60:63]
    ds_read_b64_tr_b16 v[188:189], v4 offset:4104
    v_mfma_f32_16x16x32_bf16 v[76:79], v[204:207], v[124:127], v[76:79]
    ds_read_b64_tr_b16 v[190:191], v4 offset:6152
    v_mfma_f32_16x16x32_bf16 v[16:19], v[192:195], v[112:115], v[16:19]
    v_mfma_f32_16x16x32_bf16 v[32:35], v[196:199], v[112:115], v[32:35]
    v_mfma_f32_16x16x32_bf16 v[48:51], v[200:203], v[112:115], v[48:51]
    v_mfma_f32_16x16x32_bf16 v[64:67], v[204:207], v[112:115], v[64:67]
    s_waitcnt vmcnt(8)
    v_mfma_f32_16x16x32_bf16 v[20:23], v[208:211], v[132:135], v[20:23]
    s_lshl_b32 s43, s76, 12
    s_add_u32 s43, s43, s11
    buffer_load_dwordx4 v[112:115], v5, s[60:63], s43 offen sc1
    v_mfma_f32_16x16x32_bf16 v[36:39], v[212:215], v[132:135], v[36:39]
    buffer_load_dwordx4 v[116:119], v6, s[60:63], s43 offen sc1
    v_mfma_f32_16x16x32_bf16 v[52:55], v[216:219], v[132:135], v[52:55]
    buffer_load_dwordx4 v[120:123], v7, s[60:63], s43 offen sc1
    v_mfma_f32_16x16x32_bf16 v[68:71], v[220:223], v[132:135], v[68:71]
    buffer_load_dwordx4 v[124:127], v8, s[60:63], s43 offen sc1
    v_mfma_f32_16x16x32_bf16 v[24:27], v[208:211], v[136:139], v[24:27]
    ds_read_b64_tr_b16 v[192:193], v12 offset:0
    v_mfma_f32_16x16x32_bf16 v[40:43], v[212:215], v[136:139], v[40:43]
    ds_read_b64_tr_b16 v[194:195], v12 offset:2048
    v_mfma_f32_16x16x32_bf16 v[56:59], v[216:219], v[136:139], v[56:59]
    ds_read_b64_tr_b16 v[196:197], v12 offset:8
    v_mfma_f32_16x16x32_bf16 v[72:75], v[220:223], v[136:139], v[72:75]
    ds_read_b64_tr_b16 v[198:199], v12 offset:2056
    v_mfma_f32_16x16x32_bf16 v[28:31], v[208:211], v[140:143], v[28:31]
    ds_read_b64_tr_b16 v[200:201], v13 offset:0
    v_mfma_f32_16x16x32_bf16 v[44:47], v[212:215], v[140:143], v[44:47]
    ds_read_b64_tr_b16 v[202:203], v13 offset:2048
    v_mfma_f32_16x16x32_bf16 v[60:63], v[216:219], v[140:143], v[60:63]
    ds_read_b64_tr_b16 v[204:205], v13 offset:8
    v_mfma_f32_16x16x32_bf16 v[76:79], v[220:223], v[140:143], v[76:79]
    ds_read_b64_tr_b16 v[206:207], v13 offset:2056
    v_mfma_f32_16x16x32_bf16 v[16:19], v[208:211], v[128:131], v[16:19]
    v_mfma_f32_16x16x32_bf16 v[32:35], v[212:215], v[128:131], v[32:35]
    v_mfma_f32_16x16x32_bf16 v[48:51], v[216:219], v[128:131], v[48:51]
    v_mfma_f32_16x16x32_bf16 v[64:67], v[220:223], v[128:131], v[64:67]
    s_waitcnt vmcnt(8)
    v_mfma_f32_16x16x32_bf16 v[20:23], v[224:227], v[84:87], v[20:23]
    s_lshl_b32 s43, s77, 12
    s_add_u32 s43, s43, s11
    buffer_load_dwordx4 v[128:131], v5, s[60:63], s43 offen sc1
    v_mfma_f32_16x16x32_bf16 v[36:39], v[228:231], v[84:87], v[36:39]
    buffer_load_dwordx4 v[132:135], v6, s[60:63], s43 offen sc1
    v_mfma_f32_16x16x32_bf16 v[52:55], v[232:235], v[84:87], v[52:55]
    buffer_load_dwordx4 v[136:139], v7, s[60:63], s43 offen sc1
    v_mfma_f32_16x16x32_bf16 v[68:71], v[236:239], v[84:87], v[68:71]
    buffer_load_dwordx4 v[140:143], v8, s[60:63], s43 offen sc1
    v_mfma_f32_16x16x32_bf16 v[24:27], v[224:227], v[88:91], v[24:27]
    ds_read_b64_tr_b16 v[208:209], v12 offset:4096
    v_mfma_f32_16x16x32_bf16 v[40:43], v[228:231], v[88:91], v[40:43]
    ds_read_b64_tr_b16 v[210:211], v12 offset:6144
    v_mfma_f32_16x16x32_bf16 v[56:59], v[232:235], v[88:91], v[56:59]
    ds_read_b64_tr_b16 v[212:213], v12 offset:4104
    v_mfma_f32_16x16x32_bf16 v[72:75], v[236:239], v[88:91], v[72:75]
    ds_read_b64_tr_b16 v[214:215], v12 offset:6152
    v_mfma_f32_16x16x32_bf16 v[28:31], v[224:227], v[92:95], v[28:31]
    ds_read_b64_tr_b16 v[216:217], v13 offset:4096
    v_mfma_f32_16x16x32_bf16 v[44:47], v[228:231], v[92:95], v[44:47]
    ds_read_b64_tr_b16 v[218:219], v13 offset:6144
    v_mfma_f32_16x16x32_bf16 v[60:63], v[232:235], v[92:95], v[60:63]
    ds_read_b64_tr_b16 v[220:221], v13 offset:4104
    v_mfma_f32_16x16x32_bf16 v[76:79], v[236:239], v[92:95], v[76:79]
    ds_read_b64_tr_b16 v[222:223], v13 offset:6152
    v_mfma_f32_16x16x32_bf16 v[16:19], v[224:227], v[80:83], v[16:19]
    v_mfma_f32_16x16x32_bf16 v[32:35], v[228:231], v[80:83], v[32:35]
    v_mfma_f32_16x16x32_bf16 v[48:51], v[232:235], v[80:83], v[48:51]
    v_mfma_f32_16x16x32_bf16 v[64:67], v[236:239], v[80:83], v[64:67]
    s_waitcnt vmcnt(8)
    v_mfma_f32_16x16x32_bf16 v[20:23], v[240:243], v[100:103], v[20:23]
    s_lshl_b32 s43, s78, 12
    s_add_u32 s43, s43, s11
    s_lshl_b32 s42, s3, 1
    s_lshr_b32 s68, s3, 1
    s_or_b32 s42, s42, s68
    s_and_b32 s42, s42, 3
    s_lshl_b32 s42, s42, 10
    v_add_u32 v5, s42, v1
    v_xor_b32 v6, 1024, v5
    v_xor_b32 v7, 2048, v5
    v_xor_b32 v8, 3072, v5
    buffer_load_dwordx4 v[80:83], v5, s[60:63], s43 offen sc1
    v_mfma_f32_16x16x32_bf16 v[36:39], v[244:247], v[100:103], v[36:39]
    buffer_load_dwordx4 v[84:87], v7, s[60:63], s43 offen sc1
    v_mfma_f32_16x16x32_bf16 v[52:55], v[248:251], v[100:103], v[52:55]
    buffer_load_dwordx4 v[88:91], v6, s[60:63], s43 offen sc1
    v_mfma_f32_16x16x32_bf16 v[68:71], v[252:255], v[100:103], v[68:71]
    buffer_load_dwordx4 v[92:95], v8, s[60:63], s43 offen sc1
    v_mfma_f32_16x16x32_bf16 v[24:27], v[240:243], v[104:107], v[24:27]
    ds_read_b64_tr_b16 v[224:225], v12 offset:8192
    v_mfma_f32_16x16x32_bf16 v[40:43], v[244:247], v[104:107], v[40:43]
    ds_read_b64_tr_b16 v[226:227], v12 offset:10240
    v_mfma_f32_16x16x32_bf16 v[56:59], v[248:251], v[104:107], v[56:59]
    ds_read_b64_tr_b16 v[228:229], v12 offset:8200
    v_mfma_f32_16x16x32_bf16 v[72:75], v[252:255], v[104:107], v[72:75]
    ds_read_b64_tr_b16 v[230:231], v12 offset:10248
    v_mfma_f32_16x16x32_bf16 v[28:31], v[240:243], v[108:111], v[28:31]
    ds_read_b64_tr_b16 v[232:233], v13 offset:8192
    v_mfma_f32_16x16x32_bf16 v[44:47], v[244:247], v[108:111], v[44:47]
    ds_read_b64_tr_b16 v[234:235], v13 offset:10240
    v_mfma_f32_16x16x32_bf16 v[60:63], v[248:251], v[108:111], v[60:63]
    ds_read_b64_tr_b16 v[236:237], v13 offset:8200
    v_mfma_f32_16x16x32_bf16 v[76:79], v[252:255], v[108:111], v[76:79]
    ds_read_b64_tr_b16 v[238:239], v13 offset:10248
    v_mfma_f32_16x16x32_bf16 v[16:19], v[240:243], v[96:99], v[16:19]
    v_mfma_f32_16x16x32_bf16 v[32:35], v[244:247], v[96:99], v[32:35]
    v_mfma_f32_16x16x32_bf16 v[48:51], v[248:251], v[96:99], v[48:51]
    v_mfma_f32_16x16x32_bf16 v[64:67], v[252:255], v[96:99], v[64:67]
    s_waitcnt vmcnt(8)
    s_waitcnt lgkmcnt(0)
    v_mfma_f32_16x16x32_bf16 v[20:23], v[160:163], v[116:119], v[20:23]
    s_lshl_b32 s43, s79, 12
    s_add_u32 s43, s43, s11
    buffer_load_dwordx4 v[96:99], v5, s[60:63], s43 offen sc1
    v_mfma_f32_16x16x32_bf16 v[36:39], v[164:167], v[116:119], v[36:39]
    buffer_load_dwordx4 v[100:103], v7, s[60:63], s43 offen sc1
    v_mfma_f32_16x16x32_bf16 v[52:55], v[168:171], v[116:119], v[52:55]
    buffer_load_dwordx4 v[104:107], v6, s[60:63], s43 offen sc1
    v_mfma_f32_16x16x32_bf16 v[68:71], v[172:175], v[116:119], v[68:71]
    buffer_load_dwordx4 v[108:111], v8, s[60:63], s43 offen sc1
    v_mfma_f32_16x16x32_bf16 v[24:27], v[160:163], v[120:123], v[24:27]
    v_mfma_f32_16x16x32_bf16 v[40:43], v[164:167], v[120:123], v[40:43]
    v_mfma_f32_16x16x32_bf16 v[56:59], v[168:171], v[120:123], v[56:59]
    v_mfma_f32_16x16x32_bf16 v[72:75], v[172:175], v[120:123], v[72:75]
    v_mfma_f32_16x16x32_bf16 v[28:31], v[160:163], v[124:127], v[28:31]
    v_mfma_f32_16x16x32_bf16 v[44:47], v[164:167], v[124:127], v[44:47]
    v_mfma_f32_16x16x32_bf16 v[60:63], v[168:171], v[124:127], v[60:63]
    v_mfma_f32_16x16x32_bf16 v[76:79], v[172:175], v[124:127], v[76:79]
    v_mfma_f32_16x16x32_bf16 v[16:19], v[160:163], v[112:115], v[16:19]
    v_mfma_f32_16x16x32_bf16 v[32:35], v[164:167], v[112:115], v[32:35]
    v_mfma_f32_16x16x32_bf16 v[48:51], v[168:171], v[112:115], v[48:51]
    v_mfma_f32_16x16x32_bf16 v[64:67], v[172:175], v[112:115], v[64:67]
    s_waitcnt vmcnt(8)
    s_waitcnt lgkmcnt(0)
    v_mfma_f32_16x16x32_bf16 v[20:23], v[176:179], v[132:135], v[20:23]
    s_lshl_b32 s43, s80, 12
    s_add_u32 s43, s43, s11
    buffer_load_dwordx4 v[112:115], v5, s[60:63], s43 offen sc1
    v_mfma_f32_16x16x32_bf16 v[36:39], v[180:183], v[132:135], v[36:39]
    buffer_load_dwordx4 v[116:119], v7, s[60:63], s43 offen sc1
    v_mfma_f32_16x16x32_bf16 v[52:55], v[184:187], v[132:135], v[52:55]
    buffer_load_dwordx4 v[120:123], v6, s[60:63], s43 offen sc1
    v_mfma_f32_16x16x32_bf16 v[68:71], v[188:191], v[132:135], v[68:71]
    buffer_load_dwordx4 v[124:127], v8, s[60:63], s43 offen sc1
    v_mfma_f32_16x16x32_bf16 v[24:27], v[176:179], v[136:139], v[24:27]
    v_mfma_f32_16x16x32_bf16 v[40:43], v[180:183], v[136:139], v[40:43]
    v_mfma_f32_16x16x32_bf16 v[56:59], v[184:187], v[136:139], v[56:59]
    v_mfma_f32_16x16x32_bf16 v[72:75], v[188:191], v[136:139], v[72:75]
    v_mfma_f32_16x16x32_bf16 v[28:31], v[176:179], v[140:143], v[28:31]
    v_mfma_f32_16x16x32_bf16 v[44:47], v[180:183], v[140:143], v[44:47]
    v_mfma_f32_16x16x32_bf16 v[60:63], v[184:187], v[140:143], v[60:63]
    v_mfma_f32_16x16x32_bf16 v[76:79], v[188:191], v[140:143], v[76:79]
    v_mfma_f32_16x16x32_bf16 v[16:19], v[176:179], v[128:131], v[16:19]
    v_mfma_f32_16x16x32_bf16 v[32:35], v[180:183], v[128:131], v[32:35]
    v_mfma_f32_16x16x32_bf16 v[48:51], v[184:187], v[128:131], v[48:51]
    v_mfma_f32_16x16x32_bf16 v[64:67], v[188:191], v[128:131], v[64:67]
    s_waitcnt vmcnt(8)
    s_bitcmp1_b32 s3, 0
    s_cbranch_scc1 HO_16
    v_swap_b32 v82, v84
    v_swap_b32 v83, v85
    v_swap_b32 v90, v92
    v_swap_b32 v91, v93
    s_branch HD_17
HO_16:
    v_swap_b32 v80, v86
    v_swap_b32 v81, v87
    v_swap_b32 v88, v94
    v_swap_b32 v89, v95
HD_17:
    s_nop 1
    s_waitcnt lgkmcnt(0)
    v_mfma_f32_16x16x32_bf16 v[20:23], v[192:195], v[84:87], v[20:23]
    buffer_load_dword v15, v14, s[60:63], s0 offen sc1
    v_mfma_f32_16x16x32_bf16 v[36:39], v[196:199], v[84:87], v[36:39]
    v_mfma_f32_16x16x32_bf16 v[52:55], v[200:203], v[84:87], v[52:55]
    v_mfma_f32_16x16x32_bf16 v[68:71], v[204:207], v[84:87], v[68:71]
    v_mfma_f32_16x16x32_bf16 v[24:27], v[192:195], v[88:91], v[24:27]
    v_mfma_f32_16x16x32_bf16 v[40:43], v[196:199], v[88:91], v[40:43]
    v_mfma_f32_16x16x32_bf16 v[56:59], v[200:203], v[88:91], v[56:59]
    v_mfma_f32_16x16x32_bf16 v[72:75], v[204:207], v[88:91], v[72:75]
    v_mfma_f32_16x16x32_bf16 v[28:31], v[192:195], v[92:95], v[28:31]
    v_mfma_f32_16x16x32_bf16 v[44:47], v[196:199], v[92:95], v[44:47]
    v_mfma_f32_16x16x32_bf16 v[60:63], v[200:203], v[92:95], v[60:63]
    v_mfma_f32_16x16x32_bf16 v[76:79], v[204:207], v[92:95], v[76:79]
    v_mfma_f32_16x16x32_bf16 v[16:19], v[192:195], v[80:83], v[16:19]
    v_mfma_f32_16x16x32_bf16 v[32:35], v[196:199], v[80:83], v[32:35]
    v_mfma_f32_16x16x32_bf16 v[48:51], v[200:203], v[80:83], v[48:51]
    v_mfma_f32_16x16x32_bf16 v[64:67], v[204:207], v[80:83], v[64:67]
    s_waitcnt vmcnt(5)
    s_bitcmp1_b32 s3, 0
    s_cbranch_scc1 HO_18
    v_swap_b32 v98, v100
    v_swap_b32 v99, v101
    v_swap_b32 v106, v108
    v_swap_b32 v107, v109
    s_branch HD_19
HO_18:
    v_swap_b32 v96, v102
    v_swap_b32 v97, v103
    v_swap_b32 v104, v110
    v_swap_b32 v105, v111
HD_19:
    s_nop 1
    s_waitcnt lgkmcnt(0)
    v_mfma_f32_16x16x32_bf16 v[20:23], v[208:211], v[100:103], v[20:23]
    s_xor_b32 s42, s3, 1
    s_lshl_b32 s42, s42, 14
    v_add_u32 v6, s42, v1
    v_mfma_f32_16x16x32_bf16 v[36:39], v[212:215], v[100:103], v[36:39]
    s_xor_b32 s42, s3, 2
    s_lshl_b32 s42, s42, 14
    v_add_u32 v7, s42, v1
    v_mfma_f32_16x16x32_bf16 v[52:55], v[216:219], v[100:103], v[52:55]
    s_xor_b32 s42, s3, 3
    s_lshl_b32 s42, s42, 14
    v_add_u32 v8, s42, v1
    v_mfma_f32_16x16x32_bf16 v[68:71], v[220:223], v[100:103], v[68:71]
    v_mfma_f32_16x16x32_bf16 v[24:27], v[208:211], v[104:107], v[24:27]
    v_mfma_f32_16x16x32_bf16 v[40:43], v[212:215], v[104:107], v[40:43]
    v_mfma_f32_16x16x32_bf16 v[56:59], v[216:219], v[104:107], v[56:59]
    v_mfma_f32_16x16x32_bf16 v[72:75], v[220:223], v[104:107], v[72:75]
    v_mfma_f32_16x16x32_bf16 v[28:31], v[208:211], v[108:111], v[28:31]
    v_mfma_f32_16x16x32_bf16 v[44:47], v[212:215], v[108:111], v[44:47]
    v_mfma_f32_16x16x32_bf16 v[60:63], v[216:219], v[108:111], v[60:63]
    v_mfma_f32_16x16x32_bf16 v[76:79], v[220:223], v[108:111], v[76:79]
    v_mfma_f32_16x16x32_bf16 v[16:19], v[208:211], v[96:99], v[16:19]
    v_mfma_f32_16x16x32_bf16 v[32:35], v[212:215], v[96:99], v[32:35]
    v_mfma_f32_16x16x32_bf16 v[48:51], v[216:219], v[96:99], v[48:51]
    v_mfma_f32_16x16x32_bf16 v[64:67], v[220:223], v[96:99], v[64:67]
    s_waitcnt vmcnt(0)
    v_cmp_ne_u32 vcc, s8, v15
    s_nop 1
    s_cmp_eq_u64 vcc, 0
    s_cbranch_scc1 SOK_20
    s_mov_b32 s83, 0
PF_21:
    buffer_load_dword v15, v14, s[60:63], s0 offen sc1
    s_add_u32 s83, s83, 1
    s_waitcnt vmcnt(0)
    v_cmp_ne_u32 vcc, s8, v15
    s_cmp_gt_u32 s83, 262144
    s_cbranch_scc1 PFD_22
    s_cmp_eq_u64 vcc, 0
    s_cbranch_scc1 PFD_22
    s_sleep 1
    s_branch PF_21
PFD_22:
SOK_20:
    s_add_u32 s68, s13, 32768
    buffer_load_dwordx4 v[240:243], v10, s[60:63], s13 offen sc1
    buffer_load_dwordx4 v[244:247], v10, s[60:63], s68 offen sc1
    s_bitcmp1_b32 s3, 0
    s_cbranch_scc1 HO_23
    v_swap_b32 v114, v116
    v_swap_b32 v115, v117
    v_swap_b32 v122, v124
    v_swap_b32 v123, v125
    s_branch HD_24
HO_23:
    v_swap_b32 v112, v118
    v_swap_b32 v113, v119
    v_swap_b32 v120, v126
    v_swap_b32 v121, v127
HD_24:
    s_nop 1
    s_waitcnt lgkmcnt(0)
    v_mfma_f32_16x16x32_bf16 v[20:23], v[224:227], v[116:119], v[20:23]
    v_mfma_f32_16x16x32_bf16 v[36:39], v[228:231], v[116:119], v[36:39]
    v_mfma_f32_16x16x32_bf16 v[52:55], v[232:235], v[116:119], v[52:55]
    v_mfma_f32_16x16x32_bf16 v[68:71], v[236:239], v[116:119], v[68:71]
    v_mfma_f32_16x16x32_bf16 v[24:27], v[224:227], v[120:123], v[24:27]
    v_mfma_f32_16x16x32_bf16 v[40:43], v[228:231], v[120:123], v[40:43]
    v_mfma_f32_16x16x32_bf16 v[56:59], v[232:235], v[120:123], v[56:59]
    v_mfma_f32_16x16x32_bf16 v[72:75], v[236:239], v[120:123], v[72:75]
    s_nop 0
    ds_write_b128 v156, v[20:23] offset:0
    v_mfma_f32_16x16x32_bf16 v[28:31], v[224:227], v[124:127], v[28:31]
    ds_write_b128 v156, v[36:39] offset:1024
    v_mfma_f32_16x16x32_bf16 v[44:47], v[228:231], v[124:127], v[44:47]
    ds_write_b128 v156, v[52:55] offset:2048
    v_mfma_f32_16x16x32_bf16 v[60:63], v[232:235], v[124:127], v[60:63]
    ds_write_b128 v156, v[68:71] offset:3072
    v_mfma_f32_16x16x32_bf16 v[76:79], v[236:239], v[124:127], v[76:79]
    ds_write_b128 v156, v[24:27] offset:4096
    v_mfma_f32_16x16x32_bf16 v[16:19], v[224:227], v[112:115], v[16:19]
    ds_write_b128 v156, v[40:43] offset:5120
    v_mfma_f32_16x16x32_bf16 v[32:35], v[228:231], v[112:115], v[32:35]
    ds_write_b128 v156, v[56:59] offset:6144
    v_mfma_f32_16x16x32_bf16 v[48:51], v[232:235], v[112:115], v[48:51]
    ds_write_b128 v156, v[72:75] offset:7168
    v_mfma_f32_16x16x32_bf16 v[64:67], v[236:239], v[112:115], v[64:67]
    ds_write_b128 v156, v[28:31] offset:8192
    ds_write_b128 v156, v[44:47] offset:9216
    ds_write_b128 v156, v[60:63] offset:10240
    ds_write_b128 v156, v[76:79] offset:11264
    s_setprio 3
    s_waitcnt vmcnt(0)
    ds_write_b128 v157, v[240:243]
    ds_write_b128 v157, v[244:247] offset:1024
    s_mov_b64 exec, 1
    ds_add_u32 v2, v159 offset:8
    s_mov_b64 exec, -1
    s_mov_b32 s83, 0
LW_25:
    ds_read_b32 v14, v2 offset:8
    s_add_u32 s83, s83, 1
    s_waitcnt lgkmcnt(0)
    v_readfirstlane_b32 s42, v14
    s_cmp_gt_u32 s83, 2097152
    s_cbranch_scc1 LWD_26
    s_cmp_ge_u32 s42, 8
    s_cbranch_scc1 LWD_26
    s_sleep 1
    s_branch LW_25
LWD_26:
    ds_read_b128 v[80:83], v6 offset:0
    ds_read_b128 v[84:87], v6 offset:1024
    ds_read_b128 v[88:91], v6 offset:2048
    ds_read_b128 v[92:95], v6 offset:3072
    ds_read_b128 v[96:99], v7 offset:4096
    ds_read_b128 v[100:103], v7 offset:5120
    ds_read_b128 v[104:107], v7 offset:6144
    ds_read_b128 v[108:111], v7 offset:7168
    ds_read_b128 v[112:115], v8 offset:8192
    ds_read_b128 v[116:119], v8 offset:9216
    ds_read_b128 v[120:123], v8 offset:10240
    ds_read_b128 v[124:127], v8 offset:11264
    s_waitcnt lgkmcnt(8)
    v_pk_add_f32 v[160:161], v[16:17], v[80:81]
    v_pk_add_f32 v[162:163], v[18:19], v[82:83]
    v_pk_add_f32 v[164:165], v[32:33], v[84:85]
    v_pk_add_f32 v[166:167], v[34:35], v[86:87]
    v_pk_add_f32 v[168:169], v[48:49], v[88:89]
    v_pk_add_f32 v[170:171], v[50:51], v[90:91]
    v_pk_add_f32 v[172:173], v[64:65], v[92:93]
    v_pk_add_f32 v[174:175], v[66:67], v[94:95]
    s_waitcnt lgkmcnt(4)
    v_pk_add_f32 v[160:161], v[160:161], v[96:97]
    v_pk_add_f32 v[162:163], v[162:163], v[98:99]
    v_pk_add_f32 v[164:165], v[164:165], v[100:101]
    v_pk_add_f32 v[166:167], v[166:167], v[102:103]
    v_pk_add_f32 v[168:169], v[168:169], v[104:105]
    v_pk_add_f32 v[170:171], v[170:171], v[106:107]
    v_pk_add_f32 v[172:173], v[172:173], v[108:109]
    v_pk_add_f32 v[174:175], v[174:175], v[110:111]
    s_waitcnt lgkmcnt(0)
    v_pk_add_f32 v[160:161], v[160:161], v[112:113]
    v_pk_add_f32 v[162:163], v[162:163], v[114:115]
    v_pk_add_f32 v[164:165], v[164:165], v[116:117]
    v_pk_add_f32 v[166:167], v[166:167], v[118:119]
    v_pk_add_f32 v[168:169], v[168:169], v[120:121]
    v_pk_add_f32 v[170:171], v[170:171], v[122:123]
    v_pk_add_f32 v[172:173], v[172:173], v[124:125]
    v_pk_add_f32 v[174:175], v[174:175], v[126:127]
    ds_read_b64_tr_b16 v[240:241], v158 offset:0
    ds_read_b64_tr_b16 v[242:243], v158 offset:512
    ds_read_b64_tr_b16 v[244:245], v158 offset:18432
    ds_read_b64_tr_b16 v[246:247], v158 offset:18944
    v_pk_mul_f32 v[176:177], v[160:161], s[32:33]
    v_pk_mul_f32 v[178:179], v[162:163], s[32:33]
    v_pk_mul_f32 v[180:181], v[164:165], s[32:33]
    v_pk_mul_f32 v[182:183], v[166:167], s[32:33]
    v_pk_mul_f32 v[184:185], v[168:169], s[32:33]
    v_pk_mul_f32 v[186:187], v[170:171], s[32:33]
    v_pk_mul_f32 v[188:189], v[172:173], s[32:33]
    v_pk_mul_f32 v[190:191], v[174:175], s[32:33]
    v_exp_f32 v176, v176
    v_exp_f32 v177, v177
    v_exp_f32 v178, v178
    v_exp_f32 v179, v179
    v_exp_f32 v180, v180
    v_exp_f32 v181, v181
    v_exp_f32 v182, v182
    v_exp_f32 v183, v183
    v_exp_f32 v184, v184
    v_exp_f32 v185, v185
    v_exp_f32 v186, v186
    v_exp_f32 v187, v187
    v_exp_f32 v188, v188
    v_exp_f32 v189, v189
    v_exp_f32 v190, v190
    v_exp_f32 v191, v191
    v_pk_add_f32 v[176:177], v[176:177], 1.0 op_sel_hi:[1,0]
    v_pk_add_f32 v[178:179], v[178:179], 1.0 op_sel_hi:[1,0]
    v_pk_add_f32 v[180:181], v[180:181], 1.0 op_sel_hi:[1,0]
    v_pk_add_f32 v[182:183], v[182:183], 1.0 op_sel_hi:[1,0]
    v_pk_add_f32 v[184:185], v[184:185], 1.0 op_sel_hi:[1,0]
    v_pk_add_f32 v[186:187], v[186:187], 1.0 op_sel_hi:[1,0]
    v_pk_add_f32 v[188:189], v[188:189], 1.0 op_sel_hi:[1,0]
    v_pk_add_f32 v[190:191], v[190:191], 1.0 op_sel_hi:[1,0]
    v_rcp_f32 v176, v176
    v_rcp_f32 v177, v177
    v_rcp_f32 v178, v178
    v_rcp_f32 v179, v179
    v_rcp_f32 v180, v180
    v_rcp_f32 v181, v181
    v_rcp_f32 v182, v182
    v_rcp_f32 v183, v183
    v_rcp_f32 v184, v184
    v_rcp_f32 v185, v185
    v_rcp_f32 v186, v186
    v_rcp_f32 v187, v187
    v_rcp_f32 v188, v188
    v_rcp_f32 v189, v189
    v_rcp_f32 v190, v190
    v_rcp_f32 v191, v191
    v_pk_mul_f32 v[160:161], v[160:161], v[176:177]
    v_pk_mul_f32 v[162:163], v[162:163], v[178:179]
    v_pk_mul_f32 v[164:165], v[164:165], v[180:181]
    v_pk_mul_f32 v[166:167], v[166:167], v[182:183]
    v_pk_mul_f32 v[168:169], v[168:169], v[184:185]
    v_pk_mul_f32 v[170:171], v[170:171], v[186:187]
    v_pk_mul_f32 v[172:173], v[172:173], v[188:189]
    v_pk_mul_f32 v[174:175], v[174:175], v[190:191]
    s_waitcnt lgkmcnt(0)
    v_lshlrev_b32 v176, 16, v240
    v_and_b32 v177, 0xffff0000, v240
    v_lshlrev_b32 v178, 16, v148
    v_and_b32 v179, 0xffff0000, v148
    v_pk_fma_f32 v[176:177], v[176:177], v[160:161], v[178:179]
    v_cvt_pk_bf16_f32 v148, v176, v177
    v_lshlrev_b32 v180, 16, v241
    v_and_b32 v181, 0xffff0000, v241
    v_lshlrev_b32 v182, 16, v149
    v_and_b32 v183, 0xffff0000, v149
    v_pk_fma_f32 v[180:181], v[180:181], v[162:163], v[182:183]
    v_cvt_pk_bf16_f32 v149, v180, v181
    v_lshlrev_b32 v184, 16, v242
    v_and_b32 v185, 0xffff0000, v242
    v_lshlrev_b32 v186, 16, v150
    v_and_b32 v187, 0xffff0000, v150
    v_pk_fma_f32 v[184:185], v[184:185], v[164:165], v[186:187]
    v_cvt_pk_bf16_f32 v150, v184, v185
    v_lshlrev_b32 v188, 16, v243
    v_and_b32 v189, 0xffff0000, v243
    v_lshlrev_b32 v190, 16, v151
    v_and_b32 v191, 0xffff0000, v151
    v_pk_fma_f32 v[188:189], v[188:189], v[166:167], v[190:191]
    v_cvt_pk_bf16_f32 v151, v188, v189
    buffer_store_dwordx4 v[148:151], v9, s[56:59], s9 offen offset:0 sc1
    v_lshlrev_b32 v176, 16, v244
    v_and_b32 v177, 0xffff0000, v244
    v_lshlrev_b32 v178, 16, v152
    v_and_b32 v179, 0xffff0000, v152
    v_pk_fma_f32 v[176:177], v[176:177], v[168:169], v[178:179]
    v_cvt_pk_bf16_f32 v152, v176, v177
    v_lshlrev_b32 v180, 16, v245
    v_and_b32 v181, 0xffff0000, v245
    v_lshlrev_b32 v182, 16, v153
    v_and_b32 v183, 0xffff0000, v153
    v_pk_fma_f32 v[180:181], v[180:181], v[170:171], v[182:183]
    v_cvt_pk_bf16_f32 v153, v180, v181
    v_lshlrev_b32 v184, 16, v246
    v_and_b32 v185, 0xffff0000, v246
    v_lshlrev_b32 v186, 16, v154
    v_and_b32 v187, 0xffff0000, v154
    v_pk_fma_f32 v[184:185], v[184:185], v[172:173], v[186:187]
    v_cvt_pk_bf16_f32 v154, v184, v185
    v_lshlrev_b32 v188, 16, v247
    v_and_b32 v189, 0xffff0000, v247
    v_lshlrev_b32 v190, 16, v155
    v_and_b32 v191, 0xffff0000, v155
    v_pk_fma_f32 v[188:189], v[188:189], v[174:175], v[190:191]
    v_cvt_pk_bf16_f32 v155, v188, v189
    buffer_store_dwordx4 v[152:155], v9, s[56:59], s9 offen offset:64 sc1
    s_endpgm
L_conv:
    s_setprio 2
    v_mov_b32 v15, 0
    v_lshlrev_b32 v14, 2, v0
    v_add_u32 v14, 161280, v14
    s_cmp_lg_u32 s3, 4
    s_cbranch_scc1 L_nozero
    ds_write_b32 v14, v15
L_nozero:
    s_lshl_b32 s42, s81, 5
    s_add_u32 s42, s42, s82
    s_lshl_b32 s43, s42, 2
    s_bfe_u32 s68, s3, 0x10001
    s_lshl_b32 s10, s42, 1
    s_add_u32 s10, s10, s68
    s_and_b32 s11, s3, 1
    s_and_b32 s12, s3, 3
    s_mul_i32 s6, s68, 29440
    s_add_u32 s6, s6, 102400
    s_lshl_b32 s42, s10, 8
    s_lshl_b32 s69, s11, 7
    s_add_u32 s42, s42, s69
    v_lshlrev_b32 v3, 1, v0
    s_mov_b32 s46, 131072
    s_mov_b32 s47, 0x00020000
    s_mov_b32 s50, 131072
    s_mov_b32 s51, 0x00020000
    s_mov_b32 s54, 131072
    s_mov_b32 s55, 0x00020000
    s_mov_b32 s58, 131072
    s_mov_b32 s59, 0x00020000
    s_waitcnt lgkmcnt(0)
    s_mov_b32 s44, s18
    s_and_b32 s45, s19, 0xffff
    buffer_load_ushort v4, v3, s[44:47], s42 offen
    s_mov_b32 s48, s20
    s_and_b32 s49, s21, 0xffff
    buffer_load_ushort v5, v3, s[48:51], s42 offen
    s_mov_b32 s52, s22
    s_and_b32 s53, s23, 0xffff
    buffer_load_ushort v6, v3, s[52:55], s42 offen
    s_mov_b32 s56, s24
    s_and_b32 s57, s25, 0xffff
    buffer_load_ushort v7, v3, s[56:59], s42 offen
    s_barrier
    s_load_dword s7, s[26:27], s43
    s_load_dword s9, s[28:29], s43
    s_mov_b32 s60, s40
    s_and_b32 s61, s41, 0xffff
    s_mov_b32 s62, 268435456
    s_mov_b32 s63, 0x00020000
    s_mov_b32 s64, s38
    s_and_b32 s65, s39, 0xffff
    s_mov_b32 s66, 256
    s_mov_b32 s67, 0x00020000
    s_or_b32 s77, s2, s12
    s_cmp_lg_u32 s77, 0
    s_cbranch_scc1 L_noepoch
    buffer_load_dword v255, v15, s[60:63], 0 offen sc1
L_noepoch:
    v_and_b32 v252, 15, v0
    v_lshrrev_b32 v253, 4, v0
    v_and_b32 v10, 1, v0
    v_lshlrev_b32 v10, 4, v10
    v_mov_b32 v11, 0x3f80
    v_lshlrev_b32 v10, v10, v11
    v_lshrrev_b32 v11, 1, v0
    v_cmp_eq_u32 vcc, 0, v11
    v_cmp_eq_u32 s[74:75], 1, v11
    s_nop 0
    v_cndmask_b32 v176, 0, v10, vcc
    v_cndmask_b32 v177, 0, v10, s[74:75]
    v_cmp_eq_u32 vcc, 2, v11
    v_cmp_eq_u32 s[74:75], 3, v11
    s_nop 0
    v_cndmask_b32 v178, 0, v10, vcc
    v_cndmask_b32 v179, 0, v10, s[74:75]
    v_cmp_eq_u32 vcc, 4, v11
    v_cmp_eq_u32 s[74:75], 5, v11
    s_nop 0
    v_cndmask_b32 v180, 0, v10, vcc
    v_cndmask_b32 v181, 0, v10, s[74:75]
    v_cmp_eq_u32 vcc, 6, v11
    v_cmp_eq_u32 s[74:75], 7, v11
    s_nop 0
    v_cndmask_b32 v182, 0, v10, vcc
    v_cndmask_b32 v183, 0, v10, s[74:75]
    v_cmp_eq_u32 vcc, 8, v11
    v_cmp_eq_u32 s[74:75], 9, v11
    s_nop 0
    v_cndmask_b32 v184, 0, v10, vcc
    v_cndmask_b32 v185, 0, v10, s[74:75]
    v_cmp_eq_u32 vcc, 10, v11
    v_cmp_eq_u32 s[74:75], 11, v11
    s_nop 0
    v_cndmask_b32 v186, 0, v10, vcc
    v_cndmask_b32 v187, 0, v10, s[74:75]
    v_cmp_eq_u32 vcc, 12, v11
    v_cmp_eq_u32 s[74:75], 13, v11
    s_nop 0
    v_cndmask_b32 v188, 0, v10, vcc
    v_cndmask_b32 v189, 0, v10, s[74:75]
    v_cmp_eq_u32 vcc, 14, v11
    v_cmp_eq_u32 s[74:75], 15, v11
    s_nop 0
    v_cndmask_b32 v190, 0, v10, vcc
    v_cndmask_b32 v191, 0, v10, s[74:75]
    v_cmp_eq_u32 vcc, 16, v11
    v_cmp_eq_u32 s[74:75], 17, v11
    s_nop 0
    v_cndmask_b32 v192, 0, v10, vcc
    v_cndmask_b32 v193, 0, v10, s[74:75]
    v_cmp_eq_u32 vcc, 18, v11
    v_cmp_eq_u32 s[74:75], 19, v11
    s_nop 0
    v_cndmask_b32 v194, 0, v10, vcc
    v_cndmask_b32 v195, 0, v10, s[74:75]
    v_cmp_eq_u32 vcc, 20, v11
    v_cmp_eq_u32 s[74:75], 21, v11
    s_nop 0
    v_cndmask_b32 v196, 0, v10, vcc
    v_cndmask_b32 v197, 0, v10, s[74:75]
    v_cmp_eq_u32 vcc, 22, v11
    v_cmp_eq_u32 s[74:75], 23, v11
    s_nop 0
    v_cndmask_b32 v198, 0, v10, vcc
    v_cndmask_b32 v199, 0, v10, s[74:75]
    v_cmp_eq_u32 vcc, 24, v11
    v_cmp_eq_u32 s[74:75], 25, v11
    s_nop 0
    v_cndmask_b32 v200, 0, v10, vcc
    v_cndmask_b32 v201, 0, v10, s[74:75]
    v_cmp_eq_u32 vcc, 26, v11
    v_cmp_eq_u32 s[74:75], 27, v11
    s_nop 0
    v_cndmask_b32 v202, 0, v10, vcc
    v_cndmask_b32 v203, 0, v10, s[74:75]
    v_cmp_eq_u32 vcc, 28, v11
    v_cmp_eq_u32 s[74:75], 29, v11
    s_nop 0
    v_cndmask_b32 v204, 0, v10, vcc
    v_cndmask_b32 v205, 0, v10, s[74:75]
    v_cmp_eq_u32 vcc, 30, v11
    v_cmp_eq_u32 s[74:75], 31, v11
    s_nop 0
    v_cndmask_b32 v206, 0, v10, vcc
    v_cndmask_b32 v207, 0, v10, s[74:75]
    s_lshl_b32 s42, s11, 2
    s_add_u32 s42, s42, s6
    s_add_u32 s42, s42, 16640
    v_lshrrev_b32 v10, 1, v253
    v_lshlrev_b32 v10, 7, v10
    v_and_b32 v11, 1, v253
    v_lshl_add_u32 v10, v11, 2, v10
    v_lshl_add_u32 v10, v252, 3, v10
    v_lshl_add_u32 v236, v10, 3, s42
    v_lshlrev_b32 v10, 6, v253
    v_lshlrev_b32 v11, 1, v252
    v_cmp_gt_u32 vcc, 2, v253
    v_add_u32 v10, v10, v11
    v_add_u32 v10, 256, v10
    v_cndmask_b32 v11, 0, v11, vcc
    v_add_u32 v10, v10, v11
    v_lshl_add_u32 v233, v10, 3, s42
    v_mov_b32 v11, 256
    v_cndmask_b32 v11, v11, 16, vcc
    v_add_u32 v234, v233, v11
    v_lshl_add_u32 v10, v253, 6, v252
    v_add_u32 v10, 512, v10
    v_lshl_add_u32 v235, v10, 3, s42
    s_bfe_u32 s68, s3, 0x10001
    s_lshl_b32 s68, s68, 4
    v_add_u32 v3, s68, v2
    s_waitcnt lgkmcnt(0)
    s_lshr_b32 s7, s7, s68
    s_lshl_b32 s7, s7, 16
    s_lshr_b32 s9, s9, s68
    s_lshl_b32 s9, s9, 16
    s_mov_b32 s69, 0x3fb8aa3b
    v_mov_b32 v8, s7
    v_mul_f32 v8, s69, v8
    v_exp_f32 v8, v8
    s_waitcnt vmcnt(0)
    s_cmp_lg_u32 s77, 0
    s_cbranch_scc1 NE_27
    v_add_u32 v14, 0x9e3779b8, v255
    v_or_b32 v14, 1, v14
    s_mov_b64 exec, 1
    buffer_store_dword v14, v15, s[64:67], 0 offen sc1
    buffer_store_dword v14, v15, s[60:63], 0 offen sc1
    s_mov_b64 exec, -1
NE_27:
    v_lshlrev_b32 v4, 16, v4
    v_lshlrev_b32 v5, 16, v5
    v_lshlrev_b32 v6, 16, v6
    v_lshlrev_b32 v7, 16, v7
    v_cvt_pk_bf16_f32 v8, v8, v8
    v_lshlrev_b32 v8, 16, v8
    v_mul_f32 v4, s69, v4
    v_exp_f32 v4, v4
    v_mul_f32 v5, v5, v8
    v_cvt_pk_bf16_f32 v4, v4, v4
    v_lshlrev_b32 v4, 16, v4
    v_mul_f32 v4, v4, v8
    v_mul_f32 v4, 0xbfb8aa3b, v4
    v_mul_f32 v5, 0.15915494, v5
    v_add_f32 v8, v8, v8
    v_mul_f32 v20, v6, v8
    v_mul_f32 v21, v7, v8
    v_mul_f32 v10, 0x41000000, v4
    v_mul_f32 v11, 0x41000000, v5
    v_fract_f32 v11, v11
    v_exp_f32 v10, v10
    v_cos_f32 v12, v11
    v_sin_f32 v13, v11
    v_mul_f32 v22, v10, v12
    v_mul_f32 v23, v10, v13
    v_exp_f32 v10, v4
    v_fract_f32 v11, v5
    v_cos_f32 v12, v11
    v_sin_f32 v13, v11
    v_mul_f32 v24, v10, v12
    v_mul_f32 v25, v10, v13
    v_mul_f32 v10, 0x43000000, v4
    v_mul_f32 v11, 0x43000000, v5
    v_fract_f32 v11, v11
    v_exp_f32 v10, v10
    v_cos_f32 v12, v11
    v_sin_f32 v13, v11
    v_mul_f32 v40, v10, v12
    v_mul_f32 v41, v10, v13
    v_mov_b32 v64, 1.0
    v_mov_b32 v65, 0
    v_mov_b32 v66, v22
    v_mov_b32 v67, v23
    v_mul_f32 v68, v22, v22
    v_mul_f32 v69, v22, v23
    v_fma_f32 v68, -v23, v23, v68
    v_fmac_f32 v69, v23, v22
    v_mul_f32 v26, v24, v24
    v_mul_f32 v27, v24, v25
    v_fma_f32 v26, -v25, v25, v26
    v_fmac_f32 v27, v25, v24
    v_mul_f32 v70, v66, v68
    v_mul_f32 v71, v66, v69
    v_fma_f32 v70, -v67, v69, v70
    v_fmac_f32 v71, v67, v68
    v_mul_f32 v28, v24, v26
    v_mul_f32 v29, v24, v27
    v_fma_f32 v28, -v25, v27, v28
    v_fmac_f32 v29, v25, v26
    v_mul_f32 v72, v68, v68
    v_mul_f32 v73, v68, v69
    v_fma_f32 v72, -v69, v69, v72
    v_fmac_f32 v73, v69, v68
    v_mul_f32 v30, v26, v26
    v_mul_f32 v31, v26, v27
    v_fma_f32 v30, -v27, v27, v30
    v_fmac_f32 v31, v27, v26
    v_mul_f32 v74, v70, v68
    v_mul_f32 v75, v70, v69
    v_fma_f32 v74, -v71, v69, v74
    v_fmac_f32 v75, v71, v68
    v_mul_f32 v32, v28, v26
    v_mul_f32 v33, v28, v27
    v_fma_f32 v32, -v29, v27, v32
    v_fmac_f32 v33, v29, v26
    v_mul_f32 v76, v72, v68
    v_mul_f32 v77, v72, v69
    v_fma_f32 v76, -v73, v69, v76
    v_fmac_f32 v77, v73, v68
    v_mul_f32 v34, v30, v26
    v_mul_f32 v35, v30, v27
    v_fma_f32 v34, -v31, v27, v34
    v_fmac_f32 v35, v31, v26
    v_mul_f32 v78, v74, v68
    v_mul_f32 v79, v74, v69
    v_fma_f32 v78, -v75, v69, v78
    v_fmac_f32 v79, v75, v68
    v_mul_f32 v36, v32, v26
    v_mul_f32 v37, v32, v27
    v_fma_f32 v36, -v33, v27, v36
    v_fmac_f32 v37, v33, v26
    v_mul_f32 v80, v76, v68
    v_mul_f32 v81, v76, v69
    v_fma_f32 v80, -v77, v69, v80
    v_fmac_f32 v81, v77, v68
    v_mul_f32 v82, v78, v68
    v_mul_f32 v83, v78, v69
    v_fma_f32 v82, -v79, v69, v82
    v_fmac_f32 v83, v79, v68
    v_mul_f32 v84, v80, v68
    v_mul_f32 v85, v80, v69
    v_fma_f32 v84, -v81, v69, v84
    v_fmac_f32 v85, v81, v68
    v_mul_f32 v86, v82, v68
    v_mul_f32 v87, v82, v69
    v_fma_f32 v86, -v83, v69, v86
    v_fmac_f32 v87, v83, v68
    v_mul_f32 v88, v84, v68
    v_mul_f32 v89, v84, v69
    v_fma_f32 v88, -v85, v69, v88
    v_fmac_f32 v89, v85, v68
    v_mul_f32 v90, v86, v68
    v_mul_f32 v91, v86, v69
    v_fma_f32 v90, -v87, v69, v90
    v_fmac_f32 v91, v87, v68
    v_mul_f32 v92, v88, v68
    v_mul_f32 v93, v88, v69
    v_fma_f32 v92, -v89, v69, v92
    v_fmac_f32 v93, v89, v68
    v_mul_f32 v94, v90, v68
    v_mul_f32 v95, v90, v69
    v_fma_f32 v94, -v91, v69, v94
    v_fmac_f32 v95, v91, v68
    v_mul_f32 v50, v20, v40
    v_mul_f32 v51, v20, v41
    v_fma_f32 v50, -v21, v41, v50
    v_fmac_f32 v51, v21, v40
    v_cvt_pk_bf16_f32 v96, v64, v66
    v_cvt_pk_bf16_f32 v104, -v65, -v67
    v_cvt_pk_bf16_f32 v97, v68, v70
    v_cvt_pk_bf16_f32 v105, -v69, -v71
    v_cvt_pk_bf16_f32 v98, v72, v74
    v_cvt_pk_bf16_f32 v106, -v73, -v75
    v_cvt_pk_bf16_f32 v99, v76, v78
    v_cvt_pk_bf16_f32 v107, -v77, -v79
    v_cvt_pk_bf16_f32 v100, v80, v82
    v_cvt_pk_bf16_f32 v108, -v81, -v83
    v_cvt_pk_bf16_f32 v101, v84, v86
    v_cvt_pk_bf16_f32 v109, -v85, -v87
    v_cvt_pk_bf16_f32 v102, v88, v90
    v_cvt_pk_bf16_f32 v110, -v89, -v91
    v_cvt_pk_bf16_f32 v103, v92, v94
    v_cvt_pk_bf16_f32 v111, -v93, -v95
    v_mfma_f32_16x16x32_bf16 v[112:115], v[96:99], v[176:179], 0
    v_mov_b32 v64, v20
    v_mov_b32 v65, v21
    v_mfma_f32_16x16x32_bf16 v[116:119], v[104:107], v[176:179], 0
    v_mul_f32 v66, v20, v24
    v_mul_f32 v67, v20, v25
    v_fma_f32 v66, -v21, v25, v66
    v_fmac_f32 v67, v21, v24
    v_mfma_f32_16x16x32_bf16 v[112:115], v[100:103], v[180:183], v[112:115]
    v_mul_f32 v68, v20, v26
    v_mul_f32 v69, v20, v27
    v_fma_f32 v68, -v21, v27, v68
    v_fmac_f32 v69, v21, v26
    v_mfma_f32_16x16x32_bf16 v[116:119], v[108:111], v[180:183], v[116:119]
    v_mul_f32 v70, v20, v28
    v_mul_f32 v71, v20, v29
    v_fma_f32 v70, -v21, v29, v70
    v_fmac_f32 v71, v21, v28
    v_mfma_f32_16x16x32_bf16 v[120:123], v[96:99], v[184:187], 0
    v_mul_f32 v72, v20, v30
    v_mul_f32 v73, v20, v31
    v_fma_f32 v72, -v21, v31, v72
    v_fmac_f32 v73, v21, v30
    v_mfma_f32_16x16x32_bf16 v[124:127], v[104:107], v[184:187], 0
    v_mul_f32 v74, v20, v32
    v_mul_f32 v75, v20, v33
    v_fma_f32 v74, -v21, v33, v74
    v_fmac_f32 v75, v21, v32
    v_mfma_f32_16x16x32_bf16 v[120:123], v[100:103], v[188:191], v[120:123]
    v_mul_f32 v76, v20, v34
    v_mul_f32 v77, v20, v35
    v_fma_f32 v76, -v21, v35, v76
    v_fmac_f32 v77, v21, v34
    v_mfma_f32_16x16x32_bf16 v[124:127], v[108:111], v[188:191], v[124:127]
    v_mul_f32 v78, v20, v36
    v_mul_f32 v79, v20, v37
    v_fma_f32 v78, -v21, v37, v78
    v_fmac_f32 v79, v21, v36
    v_mfma_f32_16x16x32_bf16 v[128:131], v[96:99], v[192:195], 0
    v_cvt_pk_bf16_f32 v144, v112, v113
    v_mfma_f32_16x16x32_bf16 v[132:135], v[104:107], v[192:195], 0
    v_cvt_pk_bf16_f32 v145, v114, v115
    v_mfma_f32_16x16x32_bf16 v[128:131], v[100:103], v[196:199], v[128:131]
    v_cvt_pk_bf16_f32 v146, v116, v117
    v_mfma_f32_16x16x32_bf16 v[132:135], v[108:111], v[196:199], v[132:135]
    v_cvt_pk_bf16_f32 v147, v118, v119
    v_mfma_f32_16x16x32_bf16 v[136:139], v[96:99], v[200:203], 0
    v_cvt_pk_bf16_f32 v148, v120, v121
    v_mfma_f32_16x16x32_bf16 v[140:143], v[104:107], v[200:203], 0
    v_cvt_pk_bf16_f32 v149, v122, v123
    v_mfma_f32_16x16x32_bf16 v[136:139], v[100:103], v[204:207], v[136:139]
    v_cvt_pk_bf16_f32 v150, v124, v125
    v_mfma_f32_16x16x32_bf16 v[140:143], v[108:111], v[204:207], v[140:143]
    v_cvt_pk_bf16_f32 v151, v126, v127
    v_cvt_pk_bf16_f32 v152, v128, v129
    v_cvt_pk_bf16_f32 v153, v130, v131
    v_cvt_pk_bf16_f32 v154, v132, v133
    v_cvt_pk_bf16_f32 v155, v134, v135
    s_nop 0
    v_cvt_pk_bf16_f32 v156, v136, v137
    v_cvt_pk_bf16_f32 v157, v138, v139
    v_cvt_pk_bf16_f32 v158, v140, v141
    v_cvt_pk_bf16_f32 v159, v142, v143
    v_mov_b32 v80, v50
    v_mov_b32 v81, v51
    v_mul_f32 v82, v50, v24
    v_mul_f32 v83, v50, v25
    v_fma_f32 v82, -v51, v25, v82
    v_fmac_f32 v83, v51, v24
    v_mul_f32 v84, v50, v26
    v_mul_f32 v85, v50, v27
    v_fma_f32 v84, -v51, v27, v84
    v_fmac_f32 v85, v51, v26
    v_mul_f32 v86, v50, v28
    v_mul_f32 v87, v50, v29
    v_fma_f32 v86, -v51, v29, v86
    v_fmac_f32 v87, v51, v28
    v_mul_f32 v88, v50, v30
    v_mul_f32 v89, v50, v31
    v_fma_f32 v88, -v51, v31, v88
    v_fmac_f32 v89, v51, v30
    v_mul_f32 v90, v50, v32
    v_mul_f32 v91, v50, v33
    v_fma_f32 v90, -v51, v33, v90
    v_fmac_f32 v91, v51, v32
    v_mul_f32 v92, v50, v34
    v_mul_f32 v93, v50, v35
    v_fma_f32 v92, -v51, v35, v92
    v_fmac_f32 v93, v51, v34
    v_mul_f32 v94, v50, v36
    v_mul_f32 v95, v50, v37
    v_fma_f32 v94, -v51, v37, v94
    v_fmac_f32 v95, v51, v36
    v_cvt_pk_bf16_f32 v96, v64, v66
    v_cvt_pk_bf16_f32 v104, v65, v67
    v_cvt_pk_bf16_f32 v97, v68, v70
    v_cvt_pk_bf16_f32 v105, v69, v71
    v_cvt_pk_bf16_f32 v98, v72, v74
    v_cvt_pk_bf16_f32 v106, v73, v75
    v_cvt_pk_bf16_f32 v99, v76, v78
    v_cvt_pk_bf16_f32 v107, v77, v79
    v_cvt_pk_bf16_f32 v100, v80, v82
    v_cvt_pk_bf16_f32 v108, v81, v83
    v_cvt_pk_bf16_f32 v101, v84, v86
    v_cvt_pk_bf16_f32 v109, v85, v87
    v_cvt_pk_bf16_f32 v102, v88, v90
    v_cvt_pk_bf16_f32 v110, v89, v91
    v_cvt_pk_bf16_f32 v103, v92, v94
    v_cvt_pk_bf16_f32 v111, v93, v95
    v_mfma_f32_16x16x32_bf16 v[112:115], v[96:99], v[176:179], 0
    v_mul_f32 v64, v50, v40
    v_mul_f32 v65, v50, v41
    v_fma_f32 v64, -v51, v41, v64
    v_fmac_f32 v65, v51, v40
    v_mfma_f32_16x16x32_bf16 v[116:119], v[104:107], v[176:179], 0
    v_mul_f32 v72, v64, v40
    v_mul_f32 v73, v64, v41
    v_fma_f32 v72, -v65, v41, v72
    v_fmac_f32 v73, v65, v40
    v_mfma_f32_16x16x32_bf16 v[112:115], v[100:103], v[180:183], v[112:115]
    v_mul_f32 v80, v72, v40
    v_mul_f32 v81, v72, v41
    v_fma_f32 v80, -v73, v41, v80
    v_fmac_f32 v81, v73, v40
    v_mfma_f32_16x16x32_bf16 v[116:119], v[108:111], v[180:183], v[116:119]
    v_mul_f32 v66, v64, v26
    v_mul_f32 v67, v64, v27
    v_fma_f32 v66, -v65, v27, v66
    v_fmac_f32 v67, v65, v26
    v_mfma_f32_16x16x32_bf16 v[120:123], v[96:99], v[184:187], 0
    v_mul_f32 v68, v64, v30
    v_mul_f32 v69, v64, v31
    v_fma_f32 v68, -v65, v31, v68
    v_fmac_f32 v69, v65, v30
    v_mfma_f32_16x16x32_bf16 v[124:127], v[104:107], v[184:187], 0
    v_mul_f32 v70, v64, v34
    v_mul_f32 v71, v64, v35
    v_fma_f32 v70, -v65, v35, v70
    v_fmac_f32 v71, v65, v34
    v_mfma_f32_16x16x32_bf16 v[120:123], v[100:103], v[188:191], v[120:123]
    v_mul_f32 v84, v80, v40
    v_mul_f32 v85, v80, v41
    v_fma_f32 v84, -v81, v41, v84
    v_fmac_f32 v85, v81, v40
    v_mfma_f32_16x16x32_bf16 v[124:127], v[108:111], v[188:191], v[124:127]
    v_mul_f32 v74, v72, v26
    v_mul_f32 v75, v72, v27
    v_fma_f32 v74, -v73, v27, v74
    v_fmac_f32 v75, v73, v26
    v_mfma_f32_16x16x32_bf16 v[128:131], v[96:99], v[192:195], 0
    v_cvt_pk_bf16_f32 v160, v112, v113
    v_mfma_f32_16x16x32_bf16 v[132:135], v[104:107], v[192:195], 0
    v_cvt_pk_bf16_f32 v161, v114, v115
    v_mfma_f32_16x16x32_bf16 v[128:131], v[100:103], v[196:199], v[128:131]
    v_cvt_pk_bf16_f32 v162, v116, v117
    v_mfma_f32_16x16x32_bf16 v[132:135], v[108:111], v[196:199], v[132:135]
    v_cvt_pk_bf16_f32 v163, v118, v119
    v_mfma_f32_16x16x32_bf16 v[136:139], v[96:99], v[200:203], 0
    v_cvt_pk_bf16_f32 v164, v120, v121
    v_mfma_f32_16x16x32_bf16 v[140:143], v[104:107], v[200:203], 0
    v_cvt_pk_bf16_f32 v165, v122, v123
    v_mfma_f32_16x16x32_bf16 v[136:139], v[100:103], v[204:207], v[136:139]
    v_cvt_pk_bf16_f32 v166, v124, v125
    v_mfma_f32_16x16x32_bf16 v[140:143], v[108:111], v[204:207], v[140:143]
    v_cvt_pk_bf16_f32 v167, v126, v127
    v_cvt_pk_bf16_f32 v168, v128, v129
    v_cvt_pk_bf16_f32 v169, v130, v131
    v_cvt_pk_bf16_f32 v170, v132, v133
    v_cvt_pk_bf16_f32 v171, v134, v135
    s_nop 0
    v_cvt_pk_bf16_f32 v172, v136, v137
    v_cvt_pk_bf16_f32 v173, v138, v139
    v_cvt_pk_bf16_f32 v174, v140, v141
    v_cvt_pk_bf16_f32 v175, v142, v143
    v_mul_f32 v76, v72, v30
    v_mul_f32 v77, v72, v31
    v_fma_f32 v76, -v73, v31, v76
    v_fmac_f32 v77, v73, v30
    v_mul_f32 v78, v72, v34
    v_mul_f32 v79, v72, v35
    v_fma_f32 v78, -v73, v35, v78
    v_fmac_f32 v79, v73, v34
    v_mul_f32 v88, v84, v40
    v_mul_f32 v89, v84, v41
    v_fma_f32 v88, -v85, v41, v88
    v_fmac_f32 v89, v85, v40
    v_mul_f32 v82, v80, v30
    v_mul_f32 v83, v80, v31
    v_fma_f32 v82, -v81, v31, v82
    v_fmac_f32 v83, v81, v30
    v_mul_f32 v92, v88, v40
    v_mul_f32 v93, v88, v41
    v_fma_f32 v92, -v89, v41, v92
    v_fmac_f32 v93, v89, v40
    v_mul_f32 v86, v84, v30
    v_mul_f32 v87, v84, v31
    v_fma_f32 v86, -v85, v31, v86
    v_fmac_f32 v87, v85, v30
    v_mul_f32 v50, v92, v40
    v_mul_f32 v51, v92, v41
    v_fma_f32 v50, -v93, v41, v50
    v_fmac_f32 v51, v93, v40
    v_mul_f32 v90, v88, v30
    v_mul_f32 v91, v88, v31
    v_fma_f32 v90, -v89, v31, v90
    v_fmac_f32 v91, v89, v30
    v_mul_f32 v94, v92, v30
    v_mul_f32 v95, v92, v31
    v_fma_f32 v94, -v93, v31, v94
    v_fmac_f32 v95, v93, v30
    v_cvt_pk_bf16_f32 v96, v64, v66
    v_cvt_pk_bf16_f32 v104, v65, v67
    v_cvt_pk_bf16_f32 v97, v68, v70
    v_cvt_pk_bf16_f32 v105, v69, v71
    v_cvt_pk_bf16_f32 v98, v72, v74
    v_cvt_pk_bf16_f32 v106, v73, v75
    v_cvt_pk_bf16_f32 v99, v76, v78
    v_cvt_pk_bf16_f32 v107, v77, v79
    v_cvt_pk_bf16_f32 v100, v80, v82
    v_cvt_pk_bf16_f32 v108, v81, v83
    v_cvt_pk_bf16_f32 v101, v84, v86
    v_cvt_pk_bf16_f32 v109, v85, v87
    v_cvt_pk_bf16_f32 v102, v88, v90
    v_cvt_pk_bf16_f32 v110, v89, v91
    v_cvt_pk_bf16_f32 v103, v92, v94
    v_cvt_pk_bf16_f32 v111, v93, v95
    buffer_load_dword v254, v15, s[64:67], 0 offen sc1
    v_mfma_f32_16x16x32_bf16 v[52:55], v[160:163], v[144:147], 0
    v_mov_b32 v64, v50
    v_mov_b32 v65, v51
    v_mfma_f32_16x16x32_bf16 v[52:55], v[164:167], v[148:151], v[52:55]
    v_mul_f32 v20, v40, v40
    v_mul_f32 v21, v40, v41
    v_fma_f32 v20, -v41, v41, v20
    v_fmac_f32 v21, v41, v40
    v_mfma_f32_16x16x32_bf16 v[52:55], v[168:171], v[152:155], v[52:55]
    v_mul_f32 v66, v50, v40
    v_mul_f32 v67, v50, v41
    v_fma_f32 v66, -v51, v41, v66
    v_fmac_f32 v67, v51, v40
    v_mfma_f32_16x16x32_bf16 v[52:55], v[172:175], v[156:159], v[52:55]
    v_mul_f32 v68, v64, v20
    v_mul_f32 v69, v64, v21
    v_fma_f32 v68, -v65, v21, v68
    v_fmac_f32 v69, v65, v20
    v_mfma_f32_16x16x32_bf16 v[112:115], v[96:99], v[176:179], 0
    v_mul_f32 v70, v66, v20
    v_mul_f32 v71, v66, v21
    v_fma_f32 v70, -v67, v21, v70
    v_fmac_f32 v71, v67, v20
    v_mfma_f32_16x16x32_bf16 v[116:119], v[104:107], v[176:179], 0
    v_mul_f32 v72, v68, v20
    v_mul_f32 v73, v68, v21
    v_fma_f32 v72, -v69, v21, v72
    v_fmac_f32 v73, v69, v20
    v_mfma_f32_16x16x32_bf16 v[112:115], v[100:103], v[180:183], v[112:115]
    v_mul_f32 v74, v70, v20
    v_mul_f32 v75, v70, v21
    v_fma_f32 v74, -v71, v21, v74
    v_fmac_f32 v75, v71, v20
    v_mfma_f32_16x16x32_bf16 v[116:119], v[108:111], v[180:183], v[116:119]
    v_mul_f32 v76, v72, v20
    v_mul_f32 v77, v72, v21
    v_fma_f32 v76, -v73, v21, v76
    v_fmac_f32 v77, v73, v20
    v_mfma_f32_16x16x32_bf16 v[120:123], v[96:99], v[184:187], 0
    v_mul_f32 v78, v74, v20
    v_mul_f32 v79, v74, v21
    v_fma_f32 v78, -v75, v21, v78
    v_fmac_f32 v79, v75, v20
    v_mfma_f32_16x16x32_bf16 v[124:127], v[104:107], v[184:187], 0
    v_mul_f32 v80, v76, v20
    v_mul_f32 v81, v76, v21
    v_fma_f32 v80, -v77, v21, v80
    v_fmac_f32 v81, v77, v20
    v_mfma_f32_16x16x32_bf16 v[120:123], v[100:103], v[188:191], v[120:123]
    v_mfma_f32_16x16x32_bf16 v[124:127], v[108:111], v[188:191], v[124:127]
    v_mfma_f32_16x16x32_bf16 v[128:131], v[96:99], v[192:195], 0
    v_cvt_pk_bf16_f32 v160, v112, v113
    v_mfma_f32_16x16x32_bf16 v[132:135], v[104:107], v[192:195], 0
    v_cvt_pk_bf16_f32 v161, v114, v115
    v_mfma_f32_16x16x32_bf16 v[128:131], v[100:103], v[196:199], v[128:131]
    v_cvt_pk_bf16_f32 v162, v116, v117
    v_mfma_f32_16x16x32_bf16 v[132:135], v[108:111], v[196:199], v[132:135]
    v_cvt_pk_bf16_f32 v163, v118, v119
    v_mfma_f32_16x16x32_bf16 v[136:139], v[96:99], v[200:203], 0
    v_cvt_pk_bf16_f32 v164, v120, v121
    v_mfma_f32_16x16x32_bf16 v[140:143], v[104:107], v[200:203], 0
    v_cvt_pk_bf16_f32 v165, v122, v123
    v_mfma_f32_16x16x32_bf16 v[136:139], v[100:103], v[204:207], v[136:139]
    v_cvt_pk_bf16_f32 v166, v124, v125
    v_mfma_f32_16x16x32_bf16 v[140:143], v[108:111], v[204:207], v[140:143]
    v_cvt_pk_bf16_f32 v167, v126, v127
    v_cvt_pk_bf16_f32 v168, v128, v129
    v_cvt_pk_bf16_f32 v169, v130, v131
    v_cvt_pk_bf16_f32 v170, v132, v133
    v_cvt_pk_bf16_f32 v171, v134, v135
    s_nop 0
    v_cvt_pk_bf16_f32 v172, v136, v137
    v_cvt_pk_bf16_f32 v173, v138, v139
    v_cvt_pk_bf16_f32 v174, v140, v141
    v_cvt_pk_bf16_f32 v175, v142, v143
    v_cvt_pk_bf16_f32 v96, v64, v66
    v_cvt_pk_bf16_f32 v104, v65, v67
    v_cvt_pk_bf16_f32 v97, v68, v70
    v_cvt_pk_bf16_f32 v105, v69, v71
    v_cvt_pk_bf16_f32 v98, v72, v74
    v_cvt_pk_bf16_f32 v106, v73, v75
    v_cvt_pk_bf16_f32 v99, v76, v78
    v_cvt_pk_bf16_f32 v107, v77, v79
    v_cvt_pk_bf16_f32 v100, v80, v82
    v_cvt_pk_bf16_f32 v108, v81, v83
    v_cvt_pk_bf16_f32 v101, v84, v86
    v_cvt_pk_bf16_f32 v109, v85, v87
    v_cvt_pk_bf16_f32 v102, v88, v90
    v_cvt_pk_bf16_f32 v110, v89, v91
    v_cvt_pk_bf16_f32 v103, v92, v94
    v_cvt_pk_bf16_f32 v111, v93, v95
    v_mfma_f32_16x16x32_bf16 v[56:59], v[160:163], v[144:147], 0
    ds_write_b32 v236, v52 offset:0
    v_mfma_f32_16x16x32_bf16 v[56:59], v[164:167], v[148:151], v[56:59]
    ds_write_b32 v236, v53 offset:8
    v_mfma_f32_16x16x32_bf16 v[56:59], v[168:171], v[152:155], v[56:59]
    ds_write_b32 v236, v54 offset:16
    v_mfma_f32_16x16x32_bf16 v[56:59], v[172:175], v[156:159], v[56:59]
    ds_write_b32 v236, v55 offset:24
    v_mfma_f32_16x16x32_bf16 v[112:115], v[96:99], v[176:179], 0
    v_mfma_f32_16x16x32_bf16 v[116:119], v[104:107], v[176:179], 0
    v_mfma_f32_16x16x32_bf16 v[112:115], v[100:103], v[180:183], v[112:115]
    v_mfma_f32_16x16x32_bf16 v[116:119], v[108:111], v[180:183], v[116:119]
    v_mfma_f32_16x16x32_bf16 v[120:123], v[96:99], v[184:187], 0
    v_mfma_f32_16x16x32_bf16 v[124:127], v[104:107], v[184:187], 0
    v_mfma_f32_16x16x32_bf16 v[120:123], v[100:103], v[188:191], v[120:123]
    v_mfma_f32_16x16x32_bf16 v[124:127], v[108:111], v[188:191], v[124:127]
    v_mfma_f32_16x16x32_bf16 v[128:131], v[96:99], v[192:195], 0
    s_nop 1
    v_cvt_pk_bf16_f32 v160, v112, v113
    v_mfma_f32_16x16x32_bf16 v[132:135], v[104:107], v[192:195], 0
    v_cvt_pk_bf16_f32 v161, v114, v115
    v_mfma_f32_16x16x32_bf16 v[128:131], v[100:103], v[196:199], v[128:131]
    v_cvt_pk_bf16_f32 v162, v116, v117
    v_mfma_f32_16x16x32_bf16 v[132:135], v[108:111], v[196:199], v[132:135]
    v_cvt_pk_bf16_f32 v163, v118, v119
    v_mfma_f32_16x16x32_bf16 v[136:139], v[96:99], v[200:203], 0
    v_cvt_pk_bf16_f32 v164, v120, v121
    v_mfma_f32_16x16x32_bf16 v[140:143], v[104:107], v[200:203], 0
    v_cvt_pk_bf16_f32 v165, v122, v123
    v_mfma_f32_16x16x32_bf16 v[136:139], v[100:103], v[204:207], v[136:139]
    v_cvt_pk_bf16_f32 v166, v124, v125
    v_mfma_f32_16x16x32_bf16 v[140:143], v[108:111], v[204:207], v[140:143]
    v_cvt_pk_bf16_f32 v167, v126, v127
    v_cvt_pk_bf16_f32 v168, v128, v129
    v_cvt_pk_bf16_f32 v169, v130, v131
    v_cvt_pk_bf16_f32 v170, v132, v133
    v_cvt_pk_bf16_f32 v171, v134, v135
    s_nop 0
    v_cvt_pk_bf16_f32 v172, v136, v137
    v_cvt_pk_bf16_f32 v173, v138, v139
    v_cvt_pk_bf16_f32 v174, v140, v141
    v_cvt_pk_bf16_f32 v175, v142, v143
    ds_write_b32 v233, v56 offset:0
    ds_write_b32 v233, v57 offset:8
    ds_write_b32 v234, v58 offset:0
    ds_write_b32 v234, v59 offset:8
    v_mfma_f32_16x16x32_bf16 v[60:63], v[160:163], v[144:147], 0
    v_mfma_f32_16x16x32_bf16 v[60:63], v[164:167], v[148:151], v[60:63]
    v_mfma_f32_16x16x32_bf16 v[60:63], v[168:171], v[152:155], v[60:63]
    v_mfma_f32_16x16x32_bf16 v[60:63], v[172:175], v[156:159], v[60:63]
    v_mov_b32 v14, 1
    s_lshl_b32 s42, s12, 2
    v_add_u32 v12, s42, v2
    s_nop 4
    ds_write_b32 v235, v60 offset:0
    ds_write_b32 v235, v61 offset:128
    ds_write_b32 v235, v62 offset:256
    ds_write_b32 v235, v63 offset:384
    s_mov_b64 exec, 1
    ds_add_u32 v3, v14 offset:16
    s_mov_b64 exec, -1
    s_waitcnt vmcnt(0)
    s_mov_b32 s83, 0
GT_28:
    v_readfirstlane_b32 s8, v254
    s_add_u32 s83, s83, 1
    s_cmp_gt_u32 s83, 262144
    s_cbranch_scc1 GTD_29
    s_cmp_lg_u32 s8, 0
    s_cbranch_scc1 GTD_29
    s_sleep 1
    buffer_load_dword v254, v15, s[64:67], 0 offen sc1
    s_waitcnt vmcnt(0)
    s_branch GT_28
GTD_29:
    v_mov_b32 v13, s8
    s_mov_b64 exec, 1
    ds_write_b32 v12, v13 offset:128
    s_mov_b64 exec, -1
    s_setprio 0
    v_lshlrev_b32 v10, 3, v253
    v_sub_u32 v10, v252, v10
    s_mul_i32 s42, s11, 100
    s_add_u32 s42, s42, 16
    v_add_u32 v10, s42, v10
    v_mov_b32 v12, 0xffff
    v_mov_b32 v13, 0xffff0000
    v_cmp_le_i32 vcc, 0, v10
    v_cmp_le_i32 s[72:73], 1, v10
    s_nop 0
    v_cndmask_b32 v227, 0, v12, vcc
    v_cndmask_b32 v11, 0, v13, s[72:73]
    v_or_b32 v227, v227, v11
    v_cmp_le_i32 vcc, 2, v10
    v_cmp_le_i32 s[72:73], 3, v10
    s_nop 0
    v_cndmask_b32 v228, 0, v12, vcc
    v_cndmask_b32 v11, 0, v13, s[72:73]
    v_or_b32 v228, v228, v11
    v_cmp_le_i32 vcc, 4, v10
    v_cmp_le_i32 s[72:73], 5, v10
    s_nop 0
    v_cndmask_b32 v229, 0, v12, vcc
    v_cndmask_b32 v11, 0, v13, s[72:73]
    v_or_b32 v229, v229, v11
    v_cmp_le_i32 vcc, 6, v10
    v_cmp_le_i32 s[72:73], 7, v10
    s_nop 0
    v_cndmask_b32 v230, 0, v12, vcc
    v_cndmask_b32 v11, 0, v13, s[72:73]
    v_or_b32 v230, v230, v11
    v_and_b32 v10, 3, v252
    v_mul_u32_u24 v10, 4160, v10
    v_lshrrev_b32 v11, 2, v252
    v_lshlrev_b32 v11, 3, v11
    v_sub_u32 v10, v10, v11
    v_lshl_add_u32 v10, v253, 4, v10
    s_lshl_b32 s42, s11, 8
    s_sub_u32 s42, s6, s42
    s_add_u32 s43, s42, 24
    v_add_u32 v231, s43, v10
    v_lshlrev_b32 v10, 5, v252
    v_lshl_add_u32 v10, v253, 4, v10
    s_add_u32 s43, s42, 24832
    v_add_u32 v232, s43, v10
    s_add_u32 s42, s6, 24832
    v_add_u32 v10, s42, v1
    v_mov_b32 v16, 0
    v_mov_b32 v17, 0
    v_mov_b32 v18, 0
    v_mov_b32 v19, 0
    v_cmp_gt_u32 vcc, 30, v0
    s_and_saveexec_b64 s[72:73], vcc
    ds_write_b128 v10, v[16:19]
    s_mov_b64 exec, -1
    s_lshl_b32 s42, s11, 6
    v_add_u32 v12, s42, v0
    v_lshl_add_u32 v237, v12, 5, s6
    v_lshlrev_b32 v13, 4, v12
    v_sub_u32 v13, 0x7ff, v13
    v_cvt_f32_u32 v16, v13
    s_add_u32 s43, s6, 16640
    v_lshl_add_u32 v17, v13, 3, s43
    s_add_u32 s42, s43, 1016
    v_mov_b32 v18, s42
    s_sub_u32 s42, s43, 136192
    v_mov_b32 v10, v16
    v_subrev_f32 v11, 1.0, v16
    v_cvt_pk_bf16_f32 v10, v10, v11
    v_and_b32 v11, 0x7fff, v10
    v_lshl_add_u32 v11, v11, 3, s42
    v_subrev_u32 v12, 0, v17
    v_med3_i32 v12, v12, s43, v18
    v_max_i32 v208, v11, v12
    v_bfe_u32 v11, v10, 16, 15
    v_lshl_add_u32 v11, v11, 3, s42
    v_subrev_u32 v12, 8, v17
    v_med3_i32 v12, v12, s43, v18
    v_max_i32 v209, v11, v12
    v_subrev_f32 v10, 2.0, v16
    v_subrev_f32 v11, 3.0, v16
    v_cvt_pk_bf16_f32 v10, v10, v11
    v_and_b32 v11, 0x7fff, v10
    v_lshl_add_u32 v11, v11, 3, s42
    v_subrev_u32 v12, 16, v17
    v_med3_i32 v12, v12, s43, v18
    v_max_i32 v210, v11, v12
    v_bfe_u32 v11, v10, 16, 15
    v_lshl_add_u32 v11, v11, 3, s42
    v_subrev_u32 v12, 24, v17
    v_med3_i32 v12, v12, s43, v18
    v_max_i32 v211, v11, v12
    v_subrev_f32 v10, 4.0, v16
    v_subrev_f32 v11, 5.0, v16
    v_cvt_pk_bf16_f32 v10, v10, v11
    v_and_b32 v11, 0x7fff, v10
    v_lshl_add_u32 v11, v11, 3, s42
    v_subrev_u32 v12, 32, v17
    v_med3_i32 v12, v12, s43, v18
    v_max_i32 v212, v11, v12
    v_bfe_u32 v11, v10, 16, 15
    v_lshl_add_u32 v11, v11, 3, s42
    v_subrev_u32 v12, 40, v17
    v_med3_i32 v12, v12, s43, v18
    v_max_i32 v213, v11, v12
    v_subrev_f32 v10, 6.0, v16
    v_subrev_f32 v11, 7.0, v16
    v_cvt_pk_bf16_f32 v10, v10, v11
    v_and_b32 v11, 0x7fff, v10
    v_lshl_add_u32 v11, v11, 3, s42
    v_subrev_u32 v12, 48, v17
    v_med3_i32 v12, v12, s43, v18
    v_max_i32 v214, v11, v12
    v_bfe_u32 v11, v10, 16, 15
    v_lshl_add_u32 v11, v11, 3, s42
    v_subrev_u32 v12, 56, v17
    v_med3_i32 v12, v12, s43, v18
    v_max_i32 v215, v11, v12
    v_subrev_f32 v10, 8.0, v16
    v_subrev_f32 v11, 9.0, v16
    v_cvt_pk_bf16_f32 v10, v10, v11
    v_and_b32 v11, 0x7fff, v10
    v_lshl_add_u32 v11, v11, 3, s42
    v_subrev_u32 v12, 64, v17
    v_med3_i32 v12, v12, s43, v18
    v_max_i32 v216, v11, v12
    v_bfe_u32 v11, v10, 16, 15
    v_lshl_add_u32 v11, v11, 3, s42
    v_subrev_u32 v12, 72, v17
    v_med3_i32 v12, v12, s43, v18
    v_max_i32 v217, v11, v12
    v_subrev_f32 v10, 10.0, v16
    v_subrev_f32 v11, 11.0, v16
    v_cvt_pk_bf16_f32 v10, v10, v11
    v_and_b32 v11, 0x7fff, v10
    v_lshl_add_u32 v11, v11, 3, s42
    v_subrev_u32 v12, 80, v17
    v_med3_i32 v12, v12, s43, v18
    v_max_i32 v218, v11, v12
    v_bfe_u32 v11, v10, 16, 15
    v_lshl_add_u32 v11, v11, 3, s42
    v_subrev_u32 v12, 88, v17
    v_med3_i32 v12, v12, s43, v18
    v_max_i32 v219, v11, v12
    v_subrev_f32 v10, 12.0, v16
    v_subrev_f32 v11, 13.0, v16
    v_cvt_pk_bf16_f32 v10, v10, v11
    v_and_b32 v11, 0x7fff, v10
    v_lshl_add_u32 v11, v11, 3, s42
    v_subrev_u32 v12, 96, v17
    v_med3_i32 v12, v12, s43, v18
    v_max_i32 v220, v11, v12
    v_bfe_u32 v11, v10, 16, 15
    v_lshl_add_u32 v11, v11, 3, s42
    v_subrev_u32 v12, 104, v17
    v_med3_i32 v12, v12, s43, v18
    v_max_i32 v221, v11, v12
    v_subrev_f32 v10, 14.0, v16
    v_subrev_f32 v11, 15.0, v16
    v_cvt_pk_bf16_f32 v10, v10, v11
    v_and_b32 v11, 0x7fff, v10
    v_lshl_add_u32 v11, v11, 3, s42
    v_subrev_u32 v12, 112, v17
    v_med3_i32 v12, v12, s43, v18
    v_max_i32 v222, v11, v12
    v_bfe_u32 v11, v10, 16, 15
    v_lshl_add_u32 v11, v11, 3, s42
    v_subrev_u32 v12, 120, v17
    v_med3_i32 v12, v12, s43, v18
    v_max_i32 v223, v11, v12
    v_subrev_f32 v10, 16.0, v16
    v_subrev_f32 v11, 17.0, v16
    v_cvt_pk_bf16_f32 v10, v10, v11
    v_and_b32 v11, 0x7fff, v10
    v_lshl_add_u32 v11, v11, 3, s42
    v_subrev_u32 v12, 128, v17
    v_med3_i32 v12, v12, s43, v18
    v_max_i32 v224, v11, v12
    v_bfe_u32 v11, v10, 16, 15
    v_lshl_add_u32 v11, v11, 3, s42
    v_subrev_u32 v12, 136, v17
    v_med3_i32 v12, v12, s43, v18
    v_max_i32 v225, v11, v12
    v_subrev_f32 v10, 18.0, v16
    v_subrev_f32 v11, 19.0, v16
    v_cvt_pk_bf16_f32 v10, v10, v11
    v_and_b32 v11, 0x7fff, v10
    v_lshl_add_u32 v11, v11, 3, s42
    v_subrev_u32 v12, 144, v17
    v_med3_i32 v12, v12, s43, v18
    v_max_i32 v226, v11, v12
    s_lshl_b32 s42, s81, 11
    s_add_u32 s74, s42, 4096
    s_lshr_b32 s42, s10, 2
    s_lshl_b32 s42, s42, 14
    s_and_b32 s43, s10, 2
    s_lshl_b32 s43, s43, 4
    s_add_u32 s42, s42, s43
    s_lshl_b32 s43, s12, 12
    s_add_u32 s42, s42, s43
    s_add_u32 s75, s42, 131072
    s_lshl_b32 s43, s12, 9
    s_add_u32 s74, s74, s43
    v_and_b32 v7, 0x1ff, v1
    v_lshrrev_b32 v10, 1, v0
    v_and_b32 v11, 1, v0
    v_lshlrev_b32 v9, 6, v10
    v_lshl_add_u32 v9, v11, 4, v9
    v_mul_u32_u24 v11, 29440, v11
    v_lshl_add_u32 v10, v10, 4, v11
    s_lshl_b32 s42, s12, 10
    s_add_u32 s42, s42, 127712
    v_add_u32 v8, s42, v10
    s_mov_b32 s83, 0
LW_30:
    ds_read_b32 v13, v3 offset:16
    s_add_u32 s83, s83, 1
    s_waitcnt lgkmcnt(0)
    v_readfirstlane_b32 s42, v13
    s_cmp_gt_u32 s83, 2097152
    s_cbranch_scc1 LWD_31
    s_cmp_ge_u32 s42, 2
    s_cbranch_scc1 LWD_31
    s_sleep 1
    s_branch LW_30
LWD_31:
    ds_read_b64 v[64:65], v208
    ds_read_b64 v[66:67], v209
    ds_read_b64 v[68:69], v210
    ds_read_b64 v[70:71], v211
    ds_read_b64 v[72:73], v212
    ds_read_b64 v[74:75], v213
    ds_read_b64 v[76:77], v214
    ds_read_b64 v[78:79], v215
    ds_read_b64 v[80:81], v216
    ds_read_b64 v[82:83], v217
    ds_read_b64 v[84:85], v218
    ds_read_b64 v[86:87], v219
    ds_read_b64 v[88:89], v220
    ds_read_b64 v[90:91], v221
    ds_read_b64 v[92:93], v222
    ds_read_b64 v[94:95], v223
    ds_read_b64 v[96:97], v224
    ds_read_b64 v[98:99], v225
    ds_read_b64 v[100:101], v226
    s_waitcnt lgkmcnt(0)
    v_add_f32 v64, v64, v65
    v_add_f32 v66, v66, v67
    v_add_f32 v68, v68, v69
    v_add_f32 v70, v70, v71
    v_add_f32 v72, v72, v73
    v_add_f32 v74, v74, v75
    v_add_f32 v76, v76, v77
    v_add_f32 v78, v78, v79
    v_add_f32 v80, v80, v81
    v_add_f32 v82, v82, v83
    v_add_f32 v84, v84, v85
    v_add_f32 v86, v86, v87
    v_add_f32 v88, v88, v89
    v_add_f32 v90, v90, v91
    v_add_f32 v92, v92, v93
    v_add_f32 v94, v94, v95
    v_add_f32 v96, v96, v97
    v_add_f32 v98, v98, v99
    v_add_f32 v100, v100, v101
    v_cvt_pk_bf16_f32 v112, v70, v72
    v_cvt_pk_bf16_f32 v113, v74, v76
    v_cvt_pk_bf16_f32 v114, v78, v80
    v_cvt_pk_bf16_f32 v115, v82, v84
    v_cvt_pk_bf16_f32 v116, v86, v88
    v_cvt_pk_bf16_f32 v117, v90, v92
    v_cvt_pk_bf16_f32 v118, v94, v96
    v_cvt_pk_bf16_f32 v119, v98, v100
    v_cvt_pk_bf16_f32 v120, v68, v70
    v_cvt_pk_bf16_f32 v121, v72, v74
    v_cvt_pk_bf16_f32 v122, v76, v78
    v_cvt_pk_bf16_f32 v123, v80, v82
    v_cvt_pk_bf16_f32 v124, v84, v86
    v_cvt_pk_bf16_f32 v125, v88, v90
    v_cvt_pk_bf16_f32 v126, v92, v94
    v_cvt_pk_bf16_f32 v127, v96, v98
    v_cvt_pk_bf16_f32 v128, v66, v68
    v_cvt_pk_bf16_f32 v129, v70, v72
    v_cvt_pk_bf16_f32 v130, v74, v76
    v_cvt_pk_bf16_f32 v131, v78, v80
    v_cvt_pk_bf16_f32 v132, v82, v84
    v_cvt_pk_bf16_f32 v133, v86, v88
    v_cvt_pk_bf16_f32 v134, v90, v92
    v_cvt_pk_bf16_f32 v135, v94, v96
    v_cvt_pk_bf16_f32 v136, v64, v66
    v_cvt_pk_bf16_f32 v137, v68, v70
    v_cvt_pk_bf16_f32 v138, v72, v74
    v_cvt_pk_bf16_f32 v139, v76, v78
    v_cvt_pk_bf16_f32 v140, v80, v82
    v_cvt_pk_bf16_f32 v141, v84, v86
    v_cvt_pk_bf16_f32 v142, v88, v90
    v_cvt_pk_bf16_f32 v143, v92, v94
    s_lshl_b32 s42, s12, 2
    v_add_u32 v12, s42, v2
    v_mov_b32 v14, 1
    s_mov_b32 s44, s34
    s_and_b32 s45, s35, 0xffff
    s_mov_b32 s46, 1409024
    s_mov_b32 s47, 0x00020000
    s_lshl_b32 s42, s82, 2
    s_add_u32 s42, s42, s12
    s_mul_i32 s42, s42, 43
    s_lshr_b32 s42, s42, 2
    s_lshl_b32 s42, s42, 10
    s_and_b32 s43, s81, 1
    s_lshl_b32 s43, s43, 9
    s_add_u32 s78, s42, s43
    v_lshrrev_b32 v10, 5, v0
    v_and_b32 v11, 0x1f0, v1
    v_lshl_add_u32 v10, v10, 10, v11
    s_mov_b32 s83, 0
LW_32:
    ds_read_b32 v13, v2 offset:120
    s_add_u32 s83, s83, 1
    s_waitcnt lgkmcnt(0)
    v_readfirstlane_b32 s42, v13
    s_cmp_gt_u32 s83, 2097152
    s_cbranch_scc1 LWD_33
    s_cmp_ge_u32 s42, 4
    s_cbranch_scc1 LWD_33
    s_sleep 1
    s_branch LW_32
LWD_33:
    buffer_load_dword v13, v7, s[60:63], s74 offen sc1
    buffer_load_dwordx4 v[248:251], v10, s[44:47], s78 offen offset:0
    buffer_load_dwordx4 v[248:251], v10, s[44:47], s78 offen offset:2048
    s_add_u32 s78, s78, 4096
    buffer_load_dwordx4 v[248:251], v10, s[44:47], s78 offen offset:0
    buffer_load_dwordx4 v[248:251], v10, s[44:47], s78 offen offset:2048
    s_add_u32 s78, s78, 4096
    buffer_load_dwordx4 v[248:251], v10, s[44:47], s78 offen offset:0
    buffer_load_dwordx4 v[248:251], v10, s[44:47], s78 offen offset:2048
    s_waitcnt vmcnt(6)
    v_cmp_ne_u32 vcc, s8, v13
    s_nop 1
    s_cmp_eq_u64 vcc, 0
    s_cbranch_scc1 XOK_34
    s_mov_b32 s83, 0
PF_35:
    buffer_load_dword v13, v7, s[60:63], s74 offen sc1
    s_add_u32 s83, s83, 1
    s_waitcnt vmcnt(0)
    v_cmp_ne_u32 vcc, s8, v13
    s_cmp_gt_u32 s83, 262144
    s_cbranch_scc1 PFD_36
    s_cmp_eq_u64 vcc, 0
    s_cbranch_scc1 PFD_36
    s_sleep 2
    s_branch PF_35
PFD_36:
XOK_34:
    buffer_load_dwordx4 v[16:19], v9, s[60:63], s75 offen offset:0 sc1
    buffer_load_dwordx4 v[20:23], v9, s[60:63], s75 offen offset:2048 sc1
    ds_write_b128 v237, v[112:115] offset:0
    ds_write_b128 v237, v[116:119] offset:16
    ds_write_b128 v237, v[120:123] offset:4160
    ds_write_b128 v237, v[124:127] offset:4176
    ds_write_b128 v237, v[128:131] offset:8320
    ds_write_b128 v237, v[132:135] offset:8336
    ds_write_b128 v237, v[136:139] offset:12480
    ds_write_b128 v237, v[140:143] offset:12496
    s_waitcnt vmcnt(0)
    ds_write_b128 v8, v[16:19] offset:0
    ds_write_b128 v8, v[20:23] offset:512
    s_mov_b64 exec, 1
    ds_add_u32 v2, v14 offset:48
    s_mov_b64 exec, -1
    s_setprio 2
    s_mov_b32 s83, 0
LW_37:
    ds_read_b32 v13, v2 offset:48
    s_add_u32 s83, s83, 1
    s_waitcnt lgkmcnt(0)
    v_readfirstlane_b32 s42, v13
    s_cmp_gt_u32 s83, 2097152
    s_cbranch_scc1 LWD_38
    s_cmp_ge_u32 s42, 4
    s_cbranch_scc1 LWD_38
    s_sleep 1
    s_branch LW_37
LWD_38:
    s_mov_b32 s83, 0
LW_39:
    ds_read_b32 v13, v12 offset:64
    s_add_u32 s83, s83, 1
    s_waitcnt lgkmcnt(0)
    v_readfirstlane_b32 s42, v13
    s_cmp_gt_u32 s83, 2097152
    s_cbranch_scc1 LWD_40
    s_cmp_ge_u32 s42, 1
    s_cbranch_scc1 LWD_40
    s_sleep 1
    s_branch LW_39
LWD_40:
    ds_read_b128 v[80:83], v232 offset:448
    ds_read_b64 v[48:49], v231 offset:4032
    ds_read_b64 v[50:51], v231 offset:4040
    ds_read_b128 v[84:87], v232 offset:960
    ds_read_b64 v[52:53], v231 offset:3520
    ds_read_b64 v[54:55], v231 offset:3528
    ds_read_b128 v[88:91], v232 offset:1472
    ds_read_b64 v[56:57], v231 offset:3008
    ds_read_b64 v[58:59], v231 offset:3016
    ds_read_b128 v[92:95], v232 offset:1984
    ds_read_b64 v[60:61], v231 offset:2496
    ds_read_b64 v[62:63], v231 offset:2504
    ds_read_b128 v[96:99], v232 offset:2496
    ds_read_b64 v[64:65], v231 offset:1984
    ds_read_b64 v[66:67], v231 offset:1992
    ds_read_b128 v[100:103], v232 offset:3008
    ds_read_b64 v[68:69], v231 offset:1472
    ds_read_b64 v[70:71], v231 offset:1480
    ds_read_b128 v[104:107], v232 offset:3520
    ds_read_b64 v[72:73], v231 offset:960
    ds_read_b64 v[74:75], v231 offset:968
    ds_read_b128 v[108:111], v232 offset:4032
    ds_read_b64 v[76:77], v231 offset:448
    ds_read_b64 v[78:79], v231 offset:456
    s_waitcnt lgkmcnt(0)
    v_and_b32 v48, v48, v227
    v_and_b32 v49, v49, v228
    v_and_b32 v50, v50, v229
    v_and_b32 v51, v51, v230
    s_nop 1
    v_mfma_f32_16x16x32_bf16 v[16:19], v[48:51], v[80:83], 0
    ds_read_b128 v[144:147], v232 offset:384
    v_mfma_f32_16x16x32_bf16 v[20:23], v[48:51], v[84:87], 0
    ds_read_b64 v[112:113], v231 offset:3968
    v_mfma_f32_16x16x32_bf16 v[24:27], v[48:51], v[88:91], 0
    ds_read_b64 v[114:115], v231 offset:3976
    v_mfma_f32_16x16x32_bf16 v[28:31], v[48:51], v[92:95], 0
    ds_read_b128 v[148:151], v232 offset:896
    v_mfma_f32_16x16x32_bf16 v[32:35], v[48:51], v[96:99], 0
    ds_read_b64 v[116:117], v231 offset:3456
    v_mfma_f32_16x16x32_bf16 v[36:39], v[48:51], v[100:103], 0
    ds_read_b64 v[118:119], v231 offset:3464
    v_mfma_f32_16x16x32_bf16 v[40:43], v[48:51], v[104:107], 0
    ds_read_b128 v[152:155], v232 offset:1408
    v_mfma_f32_16x16x32_bf16 v[44:47], v[48:51], v[108:111], 0
    ds_read_b64 v[120:121], v231 offset:2944
    v_mfma_f32_16x16x32_bf16 v[20:23], v[52:55], v[80:83], v[20:23]
    ds_read_b64 v[122:123], v231 offset:2952
    v_mfma_f32_16x16x32_bf16 v[24:27], v[52:55], v[84:87], v[24:27]
    ds_read_b128 v[156:159], v232 offset:1920
    v_mfma_f32_16x16x32_bf16 v[28:31], v[52:55], v[88:91], v[28:31]
    ds_read_b64 v[124:125], v231 offset:2432
    v_mfma_f32_16x16x32_bf16 v[32:35], v[52:55], v[92:95], v[32:35]
    ds_read_b64 v[126:127], v231 offset:2440
    v_mfma_f32_16x16x32_bf16 v[36:39], v[52:55], v[96:99], v[36:39]
    ds_read_b128 v[160:163], v232 offset:2432
    v_mfma_f32_16x16x32_bf16 v[40:43], v[52:55], v[100:103], v[40:43]
    ds_read_b64 v[128:129], v231 offset:1920
    v_mfma_f32_16x16x32_bf16 v[44:47], v[52:55], v[104:107], v[44:47]
    ds_read_b64 v[130:131], v231 offset:1928
    v_mfma_f32_16x16x32_bf16 v[24:27], v[56:59], v[80:83], v[24:27]
    ds_read_b128 v[164:167], v232 offset:2944
    v_mfma_f32_16x16x32_bf16 v[28:31], v[56:59], v[84:87], v[28:31]
    ds_read_b64 v[132:133], v231 offset:1408
    v_mfma_f32_16x16x32_bf16 v[32:35], v[56:59], v[88:91], v[32:35]
    ds_read_b64 v[134:135], v231 offset:1416
    v_mfma_f32_16x16x32_bf16 v[36:39], v[56:59], v[92:95], v[36:39]
    ds_read_b128 v[168:171], v232 offset:3456
    v_mfma_f32_16x16x32_bf16 v[40:43], v[56:59], v[96:99], v[40:43]
    ds_read_b64 v[136:137], v231 offset:896
    v_mfma_f32_16x16x32_bf16 v[44:47], v[56:59], v[100:103], v[44:47]
    ds_read_b64 v[138:139], v231 offset:904
    v_mfma_f32_16x16x32_bf16 v[28:31], v[60:63], v[80:83], v[28:31]
    ds_read_b128 v[172:175], v232 offset:3968
    v_mfma_f32_16x16x32_bf16 v[32:35], v[60:63], v[84:87], v[32:35]
    ds_read_b64 v[140:141], v231 offset:384
    v_mfma_f32_16x16x32_bf16 v[36:39], v[60:63], v[88:91], v[36:39]
    ds_read_b64 v[142:143], v231 offset:392
    v_mfma_f32_16x16x32_bf16 v[40:43], v[60:63], v[92:95], v[40:43]
    v_mfma_f32_16x16x32_bf16 v[44:47], v[60:63], v[96:99], v[44:47]
    v_mfma_f32_16x16x32_bf16 v[32:35], v[64:67], v[80:83], v[32:35]
    v_mfma_f32_16x16x32_bf16 v[36:39], v[64:67], v[84:87], v[36:39]
    v_mfma_f32_16x16x32_bf16 v[40:43], v[64:67], v[88:91], v[40:43]
    v_mfma_f32_16x16x32_bf16 v[44:47], v[64:67], v[92:95], v[44:47]
    v_mfma_f32_16x16x32_bf16 v[36:39], v[68:71], v[80:83], v[36:39]
    v_mfma_f32_16x16x32_bf16 v[40:43], v[68:71], v[84:87], v[40:43]
    v_mfma_f32_16x16x32_bf16 v[44:47], v[68:71], v[88:91], v[44:47]
    v_mfma_f32_16x16x32_bf16 v[40:43], v[72:75], v[80:83], v[40:43]
    v_mfma_f32_16x16x32_bf16 v[44:47], v[72:75], v[84:87], v[44:47]
    v_mfma_f32_16x16x32_bf16 v[44:47], v[76:79], v[80:83], v[44:47]
    s_waitcnt lgkmcnt(0)
    v_mfma_f32_16x16x32_bf16 v[16:19], v[112:115], v[144:147], v[16:19]
    ds_read_b128 v[80:83], v232 offset:320
    v_mfma_f32_16x16x32_bf16 v[20:23], v[112:115], v[148:151], v[20:23]
    ds_read_b64 v[48:49], v231 offset:3904
    v_mfma_f32_16x16x32_bf16 v[24:27], v[112:115], v[152:155], v[24:27]
    ds_read_b64 v[50:51], v231 offset:3912
    v_mfma_f32_16x16x32_bf16 v[28:31], v[112:115], v[156:159], v[28:31]
    ds_read_b128 v[84:87], v232 offset:832
    v_mfma_f32_16x16x32_bf16 v[32:35], v[112:115], v[160:163], v[32:35]
    ds_read_b64 v[52:53], v231 offset:3392
    v_mfma_f32_16x16x32_bf16 v[36:39], v[112:115], v[164:167], v[36:39]
    ds_read_b64 v[54:55], v231 offset:3400
    v_mfma_f32_16x16x32_bf16 v[40:43], v[112:115], v[168:171], v[40:43]
    ds_read_b128 v[88:91], v232 offset:1344
    v_mfma_f32_16x16x32_bf16 v[44:47], v[112:115], v[172:175], v[44:47]
    ds_read_b64 v[56:57], v231 offset:2880
    v_mfma_f32_16x16x32_bf16 v[20:23], v[116:119], v[144:147], v[20:23]
    ds_read_b64 v[58:59], v231 offset:2888
    v_mfma_f32_16x16x32_bf16 v[24:27], v[116:119], v[148:151], v[24:27]
    ds_read_b128 v[92:95], v232 offset:1856
    v_mfma_f32_16x16x32_bf16 v[28:31], v[116:119], v[152:155], v[28:31]
    ds_read_b64 v[60:61], v231 offset:2368
    v_mfma_f32_16x16x32_bf16 v[32:35], v[116:119], v[156:159], v[32:35]
    ds_read_b64 v[62:63], v231 offset:2376
    v_mfma_f32_16x16x32_bf16 v[36:39], v[116:119], v[160:163], v[36:39]
    ds_read_b128 v[96:99], v232 offset:2368
    v_mfma_f32_16x16x32_bf16 v[40:43], v[116:119], v[164:167], v[40:43]
    ds_read_b64 v[64:65], v231 offset:1856
    v_mfma_f32_16x16x32_bf16 v[44:47], v[116:119], v[168:171], v[44:47]
    ds_read_b64 v[66:67], v231 offset:1864
    v_mfma_f32_16x16x32_bf16 v[24:27], v[120:123], v[144:147], v[24:27]
    ds_read_b128 v[100:103], v232 offset:2880
    v_mfma_f32_16x16x32_bf16 v[28:31], v[120:123], v[148:151], v[28:31]
    ds_read_b64 v[68:69], v231 offset:1344
    v_mfma_f32_16x16x32_bf16 v[32:35], v[120:123], v[152:155], v[32:35]
    ds_read_b64 v[70:71], v231 offset:1352
    v_mfma_f32_16x16x32_bf16 v[36:39], v[120:123], v[156:159], v[36:39]
    ds_read_b128 v[104:107], v232 offset:3392
    v_mfma_f32_16x16x32_bf16 v[40:43], v[120:123], v[160:163], v[40:43]
    ds_read_b64 v[72:73], v231 offset:832
    v_mfma_f32_16x16x32_bf16 v[44:47], v[120:123], v[164:167], v[44:47]
    ds_read_b64 v[74:75], v231 offset:840
    v_mfma_f32_16x16x32_bf16 v[28:31], v[124:127], v[144:147], v[28:31]
    ds_read_b128 v[108:111], v232 offset:3904
    v_mfma_f32_16x16x32_bf16 v[32:35], v[124:127], v[148:151], v[32:35]
    ds_read_b64 v[76:77], v231 offset:320
    v_mfma_f32_16x16x32_bf16 v[36:39], v[124:127], v[152:155], v[36:39]
    ds_read_b64 v[78:79], v231 offset:328
    v_mfma_f32_16x16x32_bf16 v[40:43], v[124:127], v[156:159], v[40:43]
    v_mfma_f32_16x16x32_bf16 v[44:47], v[124:127], v[160:163], v[44:47]
    v_mfma_f32_16x16x32_bf16 v[32:35], v[128:131], v[144:147], v[32:35]
    v_mfma_f32_16x16x32_bf16 v[36:39], v[128:131], v[148:151], v[36:39]
    v_mfma_f32_16x16x32_bf16 v[40:43], v[128:131], v[152:155], v[40:43]
    v_mfma_f32_16x16x32_bf16 v[44:47], v[128:131], v[156:159], v[44:47]
    v_mfma_f32_16x16x32_bf16 v[36:39], v[132:135], v[144:147], v[36:39]
    v_mfma_f32_16x16x32_bf16 v[40:43], v[132:135], v[148:151], v[40:43]
    v_mfma_f32_16x16x32_bf16 v[44:47], v[132:135], v[152:155], v[44:47]
    v_mfma_f32_16x16x32_bf16 v[40:43], v[136:139], v[144:147], v[40:43]
    v_mfma_f32_16x16x32_bf16 v[44:47], v[136:139], v[148:151], v[44:47]
    v_mfma_f32_16x16x32_bf16 v[44:47], v[140:143], v[144:147], v[44:47]
    s_waitcnt lgkmcnt(0)
    v_mfma_f32_16x16x32_bf16 v[16:19], v[48:51], v[80:83], v[16:19]
    ds_read_b128 v[144:147], v232 offset:256
    v_mfma_f32_16x16x32_bf16 v[20:23], v[48:51], v[84:87], v[20:23]
    ds_read_b64 v[112:113], v231 offset:3840
    v_mfma_f32_16x16x32_bf16 v[24:27], v[48:51], v[88:91], v[24:27]
    ds_read_b64 v[114:115], v231 offset:3848
    v_mfma_f32_16x16x32_bf16 v[28:31], v[48:51], v[92:95], v[28:31]
    ds_read_b128 v[148:151], v232 offset:768
    v_mfma_f32_16x16x32_bf16 v[32:35], v[48:51], v[96:99], v[32:35]
    ds_read_b64 v[116:117], v231 offset:3328
    v_mfma_f32_16x16x32_bf16 v[36:39], v[48:51], v[100:103], v[36:39]
    ds_read_b64 v[118:119], v231 offset:3336
    v_mfma_f32_16x16x32_bf16 v[40:43], v[48:51], v[104:107], v[40:43]
    ds_read_b128 v[152:155], v232 offset:1280
    v_mfma_f32_16x16x32_bf16 v[44:47], v[48:51], v[108:111], v[44:47]
    ds_read_b64 v[120:121], v231 offset:2816
    v_mfma_f32_16x16x32_bf16 v[20:23], v[52:55], v[80:83], v[20:23]
    ds_read_b64 v[122:123], v231 offset:2824
    v_mfma_f32_16x16x32_bf16 v[24:27], v[52:55], v[84:87], v[24:27]
    ds_read_b128 v[156:159], v232 offset:1792
    v_mfma_f32_16x16x32_bf16 v[28:31], v[52:55], v[88:91], v[28:31]
    ds_read_b64 v[124:125], v231 offset:2304
    v_mfma_f32_16x16x32_bf16 v[32:35], v[52:55], v[92:95], v[32:35]
    ds_read_b64 v[126:127], v231 offset:2312
    v_mfma_f32_16x16x32_bf16 v[36:39], v[52:55], v[96:99], v[36:39]
    ds_read_b128 v[160:163], v232 offset:2304
    v_mfma_f32_16x16x32_bf16 v[40:43], v[52:55], v[100:103], v[40:43]
    ds_read_b64 v[128:129], v231 offset:1792
    v_mfma_f32_16x16x32_bf16 v[44:47], v[52:55], v[104:107], v[44:47]
    ds_read_b64 v[130:131], v231 offset:1800
    v_mfma_f32_16x16x32_bf16 v[24:27], v[56:59], v[80:83], v[24:27]
    ds_read_b128 v[164:167], v232 offset:2816
    v_mfma_f32_16x16x32_bf16 v[28:31], v[56:59], v[84:87], v[28:31]
    ds_read_b64 v[132:133], v231 offset:1280
    v_mfma_f32_16x16x32_bf16 v[32:35], v[56:59], v[88:91], v[32:35]
    ds_read_b64 v[134:135], v231 offset:1288
    v_mfma_f32_16x16x32_bf16 v[36:39], v[56:59], v[92:95], v[36:39]
    ds_read_b128 v[168:171], v232 offset:3328
    v_mfma_f32_16x16x32_bf16 v[40:43], v[56:59], v[96:99], v[40:43]
    ds_read_b64 v[136:137], v231 offset:768
    v_mfma_f32_16x16x32_bf16 v[44:47], v[56:59], v[100:103], v[44:47]
    ds_read_b64 v[138:139], v231 offset:776
    v_mfma_f32_16x16x32_bf16 v[28:31], v[60:63], v[80:83], v[28:31]
    ds_read_b128 v[172:175], v232 offset:3840
    v_mfma_f32_16x16x32_bf16 v[32:35], v[60:63], v[84:87], v[32:35]
    ds_read_b64 v[140:141], v231 offset:256
    v_mfma_f32_16x16x32_bf16 v[36:39], v[60:63], v[88:91], v[36:39]
    ds_read_b64 v[142:143], v231 offset:264
    v_mfma_f32_16x16x32_bf16 v[40:43], v[60:63], v[92:95], v[40:43]
    v_mfma_f32_16x16x32_bf16 v[44:47], v[60:63], v[96:99], v[44:47]
    v_mfma_f32_16x16x32_bf16 v[32:35], v[64:67], v[80:83], v[32:35]
    v_mfma_f32_16x16x32_bf16 v[36:39], v[64:67], v[84:87], v[36:39]
    v_mfma_f32_16x16x32_bf16 v[40:43], v[64:67], v[88:91], v[40:43]
    v_mfma_f32_16x16x32_bf16 v[44:47], v[64:67], v[92:95], v[44:47]
    v_mfma_f32_16x16x32_bf16 v[36:39], v[68:71], v[80:83], v[36:39]
    v_mfma_f32_16x16x32_bf16 v[40:43], v[68:71], v[84:87], v[40:43]
    v_mfma_f32_16x16x32_bf16 v[44:47], v[68:71], v[88:91], v[44:47]
    v_mfma_f32_16x16x32_bf16 v[40:43], v[72:75], v[80:83], v[40:43]
    v_mfma_f32_16x16x32_bf16 v[44:47], v[72:75], v[84:87], v[44:47]
    v_mfma_f32_16x16x32_bf16 v[44:47], v[76:79], v[80:83], v[44:47]
    s_waitcnt lgkmcnt(0)
    v_mfma_f32_16x16x32_bf16 v[16:19], v[112:115], v[144:147], v[16:19]
    s_add_u32 s42, s6, 16640
    v_mfma_f32_16x16x32_bf16 v[20:23], v[112:115], v[148:151], v[20:23]
    s_lshl_b32 s43, s11, 12
    v_mfma_f32_16x16x32_bf16 v[24:27], v[112:115], v[152:155], v[24:27]
    s_add_u32 s68, s42, s43
    v_mfma_f32_16x16x32_bf16 v[28:31], v[112:115], v[156:159], v[28:31]
    v_add_u32 v12, s68, v1
    v_mfma_f32_16x16x32_bf16 v[32:35], v[112:115], v[160:163], v[32:35]
    s_xor_b32 s43, s43, 4096
    v_mfma_f32_16x16x32_bf16 v[36:39], v[112:115], v[164:167], v[36:39]
    s_add_u32 s68, s42, s43
    v_mfma_f32_16x16x32_bf16 v[40:43], v[112:115], v[168:171], v[40:43]
    v_add_u32 v11, s68, v1
    v_mfma_f32_16x16x32_bf16 v[44:47], v[112:115], v[172:175], v[44:47]
    v_lshlrev_b32 v10, 5, v252
    v_mfma_f32_16x16x32_bf16 v[20:23], v[116:119], v[144:147], v[20:23]
    v_lshl_add_u32 v10, v253, 3, v10
    v_mfma_f32_16x16x32_bf16 v[24:27], v[116:119], v[148:151], v[24:27]
    s_lshl_b32 s42, s11, 11
    v_mfma_f32_16x16x32_bf16 v[28:31], v[116:119], v[152:155], v[28:31]
    s_add_u32 s42, s42, s6
    v_mfma_f32_16x16x32_bf16 v[32:35], v[116:119], v[156:159], v[32:35]
    s_add_u32 s42, s42, 25312
    v_mfma_f32_16x16x32_bf16 v[36:39], v[116:119], v[160:163], v[36:39]
    v_add_u32 v10, s42, v10
    v_mfma_f32_16x16x32_bf16 v[40:43], v[116:119], v[164:167], v[40:43]
    ds_read_b64 v[48:49], v10 offset:0
    v_mfma_f32_16x16x32_bf16 v[44:47], v[116:119], v[168:171], v[44:47]
    ds_read_b64 v[50:51], v10 offset:512
    v_mfma_f32_16x16x32_bf16 v[24:27], v[120:123], v[144:147], v[24:27]
    ds_read_b64 v[52:53], v10 offset:1024
    v_mfma_f32_16x16x32_bf16 v[28:31], v[120:123], v[148:151], v[28:31]
    ds_read_b64 v[54:55], v10 offset:1536
    v_mfma_f32_16x16x32_bf16 v[32:35], v[120:123], v[152:155], v[32:35]
    s_lshl_b32 s42, s10, 12
    v_mfma_f32_16x16x32_bf16 v[36:39], v[120:123], v[156:159], v[36:39]
    s_lshl_b32 s43, s11, 11
    v_mfma_f32_16x16x32_bf16 v[40:43], v[120:123], v[160:163], v[40:43]
    s_add_u32 s42, s42, s43
    v_mfma_f32_16x16x32_bf16 v[44:47], v[120:123], v[164:167], v[44:47]
    s_add_u32 s70, s42, 2228224
    v_mfma_f32_16x16x32_bf16 v[28:31], v[124:127], v[144:147], v[28:31]
    s_lshl_b32 s42, s81, 1
    v_mfma_f32_16x16x32_bf16 v[32:35], v[124:127], v[148:151], v[32:35]
    s_add_u32 s42, s42, s11
    v_mfma_f32_16x16x32_bf16 v[36:39], v[124:127], v[152:155], v[36:39]
    s_lshl_b32 s42, s42, 10
    v_mfma_f32_16x16x32_bf16 v[40:43], v[124:127], v[156:159], v[40:43]
    s_and_b32 s43, s10, 63
    v_mfma_f32_16x16x32_bf16 v[44:47], v[124:127], v[160:163], v[44:47]
    s_lshl_b32 s43, s43, 4
    v_mfma_f32_16x16x32_bf16 v[32:35], v[128:131], v[144:147], v[32:35]
    s_add_u32 s42, s42, s43
    v_mfma_f32_16x16x32_bf16 v[36:39], v[128:131], v[148:151], v[36:39]
    s_add_u32 s71, s42, 20480
    v_mfma_f32_16x16x32_bf16 v[40:43], v[128:131], v[152:155], v[40:43]
    v_mov_b32 v14, 1
    v_mfma_f32_16x16x32_bf16 v[44:47], v[128:131], v[156:159], v[44:47]
    v_mfma_f32_16x16x32_bf16 v[36:39], v[132:135], v[144:147], v[36:39]
    v_mfma_f32_16x16x32_bf16 v[40:43], v[132:135], v[148:151], v[40:43]
    v_mfma_f32_16x16x32_bf16 v[44:47], v[132:135], v[152:155], v[44:47]
    v_mfma_f32_16x16x32_bf16 v[40:43], v[136:139], v[144:147], v[40:43]
    v_mfma_f32_16x16x32_bf16 v[44:47], v[136:139], v[148:151], v[44:47]
    v_mfma_f32_16x16x32_bf16 v[44:47], v[140:143], v[144:147], v[44:47]
    s_mov_b64 exec, 1
    ds_add_u32 v2, v14 offset:8
    s_mov_b64 exec, -1
    s_cmp_eq_u32 s11, 0
    s_cbranch_scc0 L_xp1
    ds_write_b128 v12, v[32:35] offset:0
    ds_write_b128 v12, v[36:39] offset:1024
    ds_write_b128 v12, v[40:43] offset:2048
    ds_write_b128 v12, v[44:47] offset:3072
    s_mov_b64 exec, 1
    ds_add_u32 v3, v14 offset:24
    s_mov_b64 exec, -1
    s_branch L_xdone
L_xp1:
    s_nop 7
    ds_write_b128 v12, v[16:19] offset:0
    ds_write_b128 v12, v[20:23] offset:1024
    ds_write_b128 v12, v[24:27] offset:2048
    ds_write_b128 v12, v[28:31] offset:3072
    s_mov_b64 exec, 1
    ds_add_u32 v3, v14 offset:24
    s_mov_b64 exec, -1
    v_mov_b32 v16, v32
    v_mov_b32 v17, v33
    v_mov_b32 v18, v34
    v_mov_b32 v19, v35
    v_mov_b32 v20, v36
    v_mov_b32 v21, v37
    v_mov_b32 v22, v38
    v_mov_b32 v23, v39
    v_mov_b32 v24, v40
    v_mov_b32 v25, v41
    v_mov_b32 v26, v42
    v_mov_b32 v27, v43
    v_mov_b32 v28, v44
    v_mov_b32 v29, v45
    v_mov_b32 v30, v46
    v_mov_b32 v31, v47
L_xdone:
    s_waitcnt lgkmcnt(6)
    v_lshlrev_b32 v72, 16, v48
    v_and_b32 v73, 0xffff0000, v48
    v_lshlrev_b32 v74, 16, v49
    v_and_b32 v75, 0xffff0000, v49
    v_lshlrev_b32 v76, 16, v50
    v_and_b32 v77, 0xffff0000, v50
    v_lshlrev_b32 v78, 16, v51
    v_and_b32 v79, 0xffff0000, v51
    v_lshlrev_b32 v80, 16, v52
    v_and_b32 v81, 0xffff0000, v52
    v_lshlrev_b32 v82, 16, v53
    v_and_b32 v83, 0xffff0000, v53
    v_lshlrev_b32 v84, 16, v54
    v_and_b32 v85, 0xffff0000, v54
    v_lshlrev_b32 v86, 16, v55
    v_and_b32 v87, 0xffff0000, v55
    v_fma_f32 v16, v72, s9, v16
    v_fma_f32 v17, v73, s9, v17
    v_fma_f32 v18, v74, s9, v18
    v_fma_f32 v19, v75, s9, v19
    v_fma_f32 v20, v76, s9, v20
    v_fma_f32 v21, v77, s9, v21
    v_fma_f32 v22, v78, s9, v22
    v_fma_f32 v23, v79, s9, v23
    v_fma_f32 v24, v80, s9, v24
    v_fma_f32 v25, v81, s9, v25
    v_fma_f32 v26, v82, s9, v26
    v_fma_f32 v27, v83, s9, v27
    v_fma_f32 v28, v84, s9, v28
    v_fma_f32 v29, v85, s9, v29
    v_fma_f32 v30, v86, s9, v30
    v_fma_f32 v31, v87, s9, v31
    s_mov_b32 s83, 0
LW_41:
    ds_read_b32 v13, v3 offset:24
    s_add_u32 s83, s83, 1
    s_waitcnt lgkmcnt(0)
    v_readfirstlane_b32 s42, v13
    s_cmp_gt_u32 s83, 2097152
    s_cbranch_scc1 LWD_42
    s_cmp_ge_u32 s42, 2
    s_cbranch_scc1 LWD_42
    s_sleep 1
    s_branch LW_41
LWD_42:
    ds_read_b128 v[48:51], v11 offset:0
    ds_read_b128 v[52:55], v11 offset:1024
    ds_read_b128 v[56:59], v11 offset:2048
    ds_read_b128 v[60:63], v11 offset:3072
    s_waitcnt lgkmcnt(2)
    v_add_f32 v16, v16, v48
    v_add_f32 v17, v17, v49
    v_add_f32 v18, v18, v50
    v_add_f32 v19, v19, v51
    v_add_f32 v20, v20, v52
    v_add_f32 v21, v21, v53
    v_add_f32 v22, v22, v54
    v_add_f32 v23, v23, v55
    v_cvt_pk_bf16_f32 v64, v16, v17
    v_cvt_pk_bf16_f32 v65, v18, v19
    v_cvt_pk_bf16_f32 v66, v20, v21
    v_cvt_pk_bf16_f32 v67, v22, v23
    s_nop 0
    v_permlane16_swap_b32 v64, v66
    v_permlane16_swap_b32 v65, v67
    buffer_store_dwordx4 v[64:67], v1, s[60:63], s70 offen offset:0 sc1
    s_waitcnt lgkmcnt(0)
    v_add_f32 v24, v24, v56
    v_add_f32 v25, v25, v57
    v_add_f32 v26, v26, v58
    v_add_f32 v27, v27, v59
    v_add_f32 v28, v28, v60
    v_add_f32 v29, v29, v61
    v_add_f32 v30, v30, v62
    v_add_f32 v31, v31, v63
    v_cvt_pk_bf16_f32 v68, v24, v25
    v_cvt_pk_bf16_f32 v69, v26, v27
    v_cvt_pk_bf16_f32 v70, v28, v29
    v_cvt_pk_bf16_f32 v71, v30, v31
    s_nop 0
    v_permlane16_swap_b32 v68, v70
    v_permlane16_swap_b32 v69, v71
    buffer_store_dwordx4 v[68:71], v1, s[60:63], s70 offen offset:1024 sc1
    s_waitcnt vmcnt(0)
    v_mov_b32 v14, s8
    s_mov_b64 exec, 1
    buffer_store_dword v14, v15, s[60:63], s71 offen sc1
    s_mov_b64 exec, -1
L_end:
    s_endpgm
L_code_end:
.section .rodata,"a"
.p2align 6
.amdhsa_kernel recurrent_scan__ssm_conv_s4d__dense_activation_silu__prompt_kernel
  .amdhsa_next_free_vgpr 256
  .amdhsa_next_free_sgpr 102
  .amdhsa_accum_offset 256
  .amdhsa_group_segment_fixed_size 0
  .amdhsa_kernarg_size 104
  .amdhsa_user_sgpr_count 2
  .amdhsa_user_sgpr_kernarg_segment_ptr 1
  .amdhsa_system_sgpr_workgroup_id_x 1
.end_amdhsa_kernel
```
